```python
import torch

def _softmax(x, axis=-1):
    return torch.softmax(x, dim=axis)
def _gelu(x):
    return torch.nn.functional.gelu(x, approximate="tanh")
def _silu(x):
    return torch.nn.functional.silu(x)
def _sigmoid(x):
    return torch.sigmoid(x)
def _layernorm(x, axis=-1, eps=1e-5):
    m = x.mean(dim=axis, keepdim=True)
    v = x.var(dim=axis, keepdim=True, unbiased=False)
    return (x - m) / torch.sqrt(v + eps)
def _scatter_add(tgt, idx, src, axis=0):
    return tgt.clone().index_add_(axis, idx, src)
def _segment_sum(src, seg, n):
    out = torch.zeros((n,) + src.shape[1:], dtype=src.dtype)
    return out.index_add_(0, seg, src)
def _pad(x, pw):
    flat = tuple(v for pair in reversed(pw) for v in pair)
    return torch.nn.functional.pad(x, flat)

kernel_name = 'sequential_preLN__sliding_block_cached__swiglu_ffn__decode'

def setup_inputs():

    _w = (lambda a: (lambda t: t.to(torch.bfloat16) if t.is_floating_point() else t)(torch.as_tensor(a)))
    def _A_setup():
        B, Sq, D = 2, 1, 640
        Hq, Hkv, Sk, Dh = 32, 32, 4096, 128
        assert Hq % Hkv == 0, (Hq, Hkv)
        return {
            "x": _w((lambda *s: torch.randn(*s, dtype=torch.bfloat16) * 0.05)(B, Sq, D)),
            "k_cache": _w((lambda *s: torch.randn(*s, dtype=torch.bfloat16) * 3.2)(B, Hkv, Sk, Dh)),
            "v_cache": _w((lambda *s: torch.randn(*s, dtype=torch.bfloat16) * 0.4)(B, Hkv, Sk, Dh)),
            "wq": _w((lambda *s: torch.randn(*s, dtype=torch.bfloat16) * 3.2)(D, Hq * Dh) * (D ** -0.5)),
            "wo": _w((lambda *s: torch.randn(*s, dtype=torch.bfloat16) * 0.4)(Hq * Dh, D) * ((Hq * Dh) ** -0.5)),
        }
    _A_in = _A_setup()

    def _B_setup():
        B, S, D, F = 2, 1, 640, 1728
        return {
            "x": _w((lambda *s: torch.randn(*s, dtype=torch.bfloat16) * 0.05)(B, S, D)),
            "w_gate": _w((lambda *s: torch.randn(*s, dtype=torch.bfloat16) * 0.05)(D, F)),
            "w_up": _w((lambda *s: torch.randn(*s, dtype=torch.bfloat16) * 0.05)(D, F)),
            "w_down": _w((lambda *s: torch.randn(*s, dtype=torch.bfloat16) * 0.05)(F, D)),
        }
    _B_in = _B_setup()

    return {
        "A_x": _A_in["x"],
        "A_k_cache": _A_in["k_cache"],
        "A_v_cache": _A_in["v_cache"],
        "A_wq": _A_in["wq"],
        "A_wo": _A_in["wo"],
        "B_x": _B_in["x"],
        "B_w_gate": _B_in["w_gate"],
        "B_w_up": _B_in["w_up"],
        "B_w_down": _B_in["w_down"],
    }

def reference(A_x, A_k_cache, A_v_cache, A_wq, A_wo, B_x, B_w_gate, B_w_up, B_w_down):
    def _A_ref(x, k_cache, v_cache, wq, wo):
        B, Sq, D = x.shape
        Hq, Dh = 32, 128
        Hkv, Sk = k_cache.shape[1], k_cache.shape[2]
        W = min(4096, max(256, Sk // 4))
        rep = Hq // Hkv
        q = (lambda x, *d: x.permute(*d))((x @ wq).reshape(B, Sq, Hq, Dh), 0, 2, 1, 3)
        k = (lambda x, n, axis: torch.repeat_interleave(x, n, dim=axis))(k_cache[:, :, Sk - W:, :], rep, axis=1)
        v = (lambda x, n, axis: torch.repeat_interleave(x, n, dim=axis))(v_cache[:, :, Sk - W:, :], rep, axis=1)
        scores = torch.einsum("bhqd,bhkd->bhqk", q, k) * (Dh ** -0.5)
        p = _softmax(scores, axis=-1)
        o = torch.einsum("bhqk,bhkd->bhqd", p, v)
        return (lambda x, *d: x.permute(*d))(o, 0, 2, 1, 3).reshape(B, Sq, Hq * Dh) @ wo

    def _B_ref(x, w_gate, w_up, w_down):
        g = _silu(x @ w_gate)
        u = x @ w_up
        return (g * u) @ w_down

    x = A_x
    h = x + _A_ref(_layernorm(x, axis=-1), A_k_cache, A_v_cache, A_wq, A_wo)
    h2 = h + _B_ref(_layernorm(h, axis=-1), B_w_gate, B_w_up, B_w_down)
    return h2
```

```asm
; @launch grid=(256,1,1) block=(384,1,1) lds=147456
.amdgcn_target "amdgcn-amd-amdhsa--gfx950"
.text
.globl sequential_preLN__sliding_block_cached__swiglu_ffn__decode_kernel
.p2align 8
.type sequential_preLN__sliding_block_cached__swiglu_ffn__decode_kernel,@function
sequential_preLN__sliding_block_cached__swiglu_ffn__decode_kernel:
    s_cmp_ge_u32 s2, 256
    s_cbranch_scc1 L_exit
    s_load_dwordx16 s[16:31], s[0:1], 0
    s_load_dwordx8 s[32:39], s[0:1], 64
    s_getpc_b64 s[56:57]
L_pc:
    s_lshr_b32 s5, s2, 3
    s_lshl_b32 s44, s5, 10
    v_lshl_add_u32 v8, v0, 6, s44
    v_min_u32 v8, L_exit-L_pc, v8
    v_cmp_gt_u32 vcc, 16, v0
    s_and_saveexec_b64 s[44:45], vcc
    s_cbranch_execz L_npf
    global_load_dword v199, v8, s[56:57]
L_npf:
    s_mov_b64 exec, -1
    v_lshrrev_b32 v1, 6, v0
    v_and_b32 v0, 63, v0
    v_readfirstlane_b32 s3, v1
    s_and_b32 s4, s2, 7
    s_and_b32 s6, s5, 3
    s_lshl_b32 s44, s4, 2
    s_add_u32 s6, s6, s44
    s_lshr_b32 s7, s5, 2
    s_lshr_b32 s8, s7, 2
    s_and_b32 s9, s7, 3
    v_and_b32 v1, 15, v0
    v_lshrrev_b32 v2, 4, v0
    v_mov_b32 v190, 0
    s_sub_u32 s10, s3, 1
    s_cmp_eq_u32 s3, 5
    s_cbranch_scc1 L_load
    s_cmp_eq_u32 s3, 0
    s_cbranch_scc1 L_comm
    s_lshl_b32 s44, s8, 5
    s_add_u32 s44, s44, s6
    s_lshl_b32 s44, s44, 20
    s_lshl_b32 s45, s9, 16
    s_add_u32 s44, s44, s45
    s_lshl_b32 s45, s10, 14
    s_add_u32 s44, s44, s45
    s_add_u32 s44, s44, 786432
    s_and_b32 s46, s10, 1
    s_lshl_b32 s46, s46, 13
    s_add_u32 s44, s44, s46
    s_lshl_b32 s46, s46, 1
    s_sub_u32 s57, 4096, s46
    v_xor_b32 v12, v1, v2
    v_lshlrev_b32 v13, 8, v2
    v_add_u32 v13, s44, v13
    v_xor_b32 v8, 0, v12
    v_lshl_add_u32 v8, v8, 4, v13
    v_xor_b32 v9, 4, v12
    v_lshl_add_u32 v9, v9, 4, v13
    v_add_u32 v9, 1024, v9
    v_xor_b32 v10, 8, v12
    v_lshl_add_u32 v10, v10, 4, v13
    v_add_u32 v10, 2048, v10
    v_xor_b32 v11, 12, v12
    v_lshl_add_u32 v11, v11, 4, v13
    v_add_u32 v11, 3072, v11
    s_lshl_b32 s44, s10, 2
    v_mov_b32 v191, s44
    s_add_u32 s56, s45, 16384
    s_waitcnt lgkmcnt(0)
    s_add_u32 m0, s56, 0
    s_nop 0
    global_load_lds_dwordx4 v8, s[18:19] nt
    v_add_u32 v8, 4096, v8
    s_add_u32 m0, s56, 1024
    s_nop 0
    global_load_lds_dwordx4 v9, s[18:19] nt
    v_add_u32 v9, 4096, v9
    s_add_u32 m0, s56, 2048
    s_nop 0
    global_load_lds_dwordx4 v10, s[18:19] nt
    v_add_u32 v10, 4096, v10
    s_add_u32 m0, s56, 3072
    s_nop 0
    global_load_lds_dwordx4 v11, s[18:19] nt
    v_add_u32 v11, 4096, v11
    s_barrier
    s_branch L_att
L_load:
    v_mov_b32 v8, -1
    v_lshlrev_b32 v9, 2, v0
    s_mov_b32 exec_hi, 0
    ds_write_b32 v9, v8 offset:0
    s_mov_b64 exec, -1
    s_waitcnt lgkmcnt(0)
    s_load_dword s11, s[38:39], 0
    s_barrier
    s_branch L_load2
L_comm:
    s_sub_u32 s100, s5, 12
    s_max_i32 s100, s100, 0
    s_add_u32 s101, s5, 12
    s_cmp_lt_u32 s5, 12
    s_cselect_b32 s101, s5, s101
    s_sub_u32 s44, s5, 8
    s_cmp_ge_u32 s5, 20
    s_cselect_b32 s101, s44, s101
    v_bfe_u32 v8, v0, 3, 1
    v_mul_u32_u24 v8, 1280, v8
    v_and_b32 v9, 7, v0
    v_lshl_add_u32 v9, v2, 3, v9
    v_mul_u32_u24 v9, 40, v9
    v_add_u32 v10, v8, v9
    s_mul_i32 s44, s7, 160
    v_mul_u32_u24 v9, 40, v2
    v_add3_u32 v11, v8, v9, s44
    s_mul_i32 s44, s7, 655360
    s_lshl_b32 s45, s6, 8
    s_add_u32 s44, s44, s45
    v_mul_u32_u24 v12, 163840, v2
    v_lshl_add_u32 v12, v1, 4, v12
    v_add_u32 v12, s44, v12
    v_and_b32 v8, 1, v1
    v_mul_u32_u24 v8, 1280, v8
    v_lshrrev_b32 v13, 1, v1
    v_lshl_add_u32 v13, v13, 3, v8
    v_lshl_add_u32 v13, v2, 1, v13
    s_lshl_b32 s44, s100, 6
    v_add_u32 v13, s44, v13
    s_waitcnt lgkmcnt(0)
    s_load_dword s11, s[38:39], 0
    global_load_dwordx4 v[96:99], v10, s[16:17]
    global_load_dwordx4 v[100:103], v10, s[16:17] offset:16
    global_load_dwordx2 v[104:105], v10, s[16:17] offset:32
    global_load_dwordx4 v[106:109], v11, s[16:17]
    global_load_dwordx4 v[110:113], v11, s[16:17] offset:16
    global_load_dwordx2 v[114:115], v11, s[16:17] offset:32
    global_load_ushort v14, v13, s[16:17]
    global_load_dwordx4 v[16:19], v12, s[22:23] nt
    v_add_u32 v12, 8192, v12
    global_load_dwordx4 v[20:23], v12, s[22:23] nt
    v_add_u32 v12, 8192, v12
    global_load_dwordx4 v[24:27], v12, s[22:23] nt
    v_add_u32 v12, 8192, v12
    global_load_dwordx4 v[28:31], v12, s[22:23] nt
    v_add_u32 v12, 8192, v12
    global_load_dwordx4 v[32:35], v12, s[22:23] nt
    v_add_u32 v12, 8192, v12
    global_load_dwordx4 v[36:39], v12, s[22:23] nt
    v_add_u32 v12, 8192, v12
    global_load_dwordx4 v[40:43], v12, s[22:23] nt
    v_add_u32 v12, 8192, v12
    global_load_dwordx4 v[44:47], v12, s[22:23] nt
    v_add_u32 v12, 8192, v12
    global_load_dwordx4 v[48:51], v12, s[22:23] nt
    v_add_u32 v12, 8192, v12
    global_load_dwordx4 v[52:55], v12, s[22:23] nt
    v_add_u32 v12, 8192, v12
    global_load_dwordx4 v[56:59], v12, s[22:23] nt
    v_add_u32 v12, 8192, v12
    global_load_dwordx4 v[60:63], v12, s[22:23] nt
    v_add_u32 v12, 8192, v12
    global_load_dwordx4 v[64:67], v12, s[22:23] nt
    v_add_u32 v12, 8192, v12
    global_load_dwordx4 v[68:71], v12, s[22:23] nt
    v_add_u32 v12, 8192, v12
    global_load_dwordx4 v[72:75], v12, s[22:23] nt
    v_add_u32 v12, 8192, v12
    global_load_dwordx4 v[76:79], v12, s[22:23] nt
    v_add_u32 v12, 8192, v12
    global_load_dwordx4 v[80:83], v12, s[22:23] nt
    v_add_u32 v12, 8192, v12
    global_load_dwordx4 v[84:87], v12, s[22:23] nt
    v_add_u32 v12, 8192, v12
    global_load_dwordx4 v[88:91], v12, s[22:23] nt
    v_add_u32 v12, 8192, v12
    global_load_dwordx4 v[92:95], v12, s[22:23] nt
    s_barrier
    s_setprio 3
    s_and_b32 s45, s2, 127
    s_lshl_b32 s45, s45, 6
    s_lshr_b32 s46, s2, 7
    s_lshl_b32 s46, s46, 14
    s_add_u32 s45, s45, s46
    s_add_u32 s45, s45, 1376256
    s_add_u32 s92, s38, s45
    s_addc_u32 s93, s39, 0
    s_load_dword s48, s[92:93], 0 glc
    s_load_dword s49, s[92:93], 8192 glc
    s_mov_b32 s94, -1
    s_mov_b32 s95, -1
    v_and_b32 v8, 7, v0
    v_and_b32 v9, 1, v8
    v_cmp_eq_u32 vcc, 1, v9
    v_mov_b32 v9, 0xffff
    v_mov_b32 v10, 0xffff0000
    v_cndmask_b32 v9, v9, v10, vcc
    v_lshrrev_b32 v8, 1, v8
    v_cmp_eq_u32 vcc, 0, v8
    s_nop 1
    v_cndmask_b32 v3, 0, v9, vcc
    v_cmp_eq_u32 vcc, 1, v8
    s_nop 1
    v_cndmask_b32 v4, 0, v9, vcc
    v_cmp_eq_u32 vcc, 2, v8
    s_nop 1
    v_cndmask_b32 v5, 0, v9, vcc
    v_cmp_eq_u32 vcc, 3, v8
    s_nop 1
    v_cndmask_b32 v6, 0, v9, vcc
    v_mov_b32 v7, 0xffffff00
    s_mov_b32 s53, 0x0c0c0400
    s_mov_b32 s58, 0xff00ff00
    s_mov_b32 s59, 0xff00ff00
    s_getreg_b32 s54, hwreg(HW_REG_XCC_ID)
    s_and_b32 s54, s54, 0xf
    v_and_b32 v10, 31, v0
    s_lshl_b32 s44, s4, 12
    s_add_u32 s44, s44, 8192
    v_lshlrev_b32 v142, 7, v10
    v_add_u32 v142, s44, v142
    s_lshl_b32 s44, s6, 10
    s_add_u32 s44, s44, 8192
    v_and_b32 v9, 7, v0
    v_lshlrev_b32 v143, 7, v9
    v_add_u32 v143, s44, v143
    s_lshl_b32 s44, s6, 14
    s_add_u32 s44, s44, 65536
    v_lshrrev_b32 v9, 1, v2
    v_lshlrev_b32 v9, 13, v9
    v_and_b32 v10, 1, v2
    v_lshl_add_u32 v10, v1, 1, v10
    v_lshl_add_u32 v12, v10, 4, v9
    v_add_u32 v12, s44, v12
    s_and_b32 s45, s7, 1
    s_lshl_b32 s45, s45, 9
    s_lshr_b32 s46, s7, 1
    s_lshl_b32 s46, s46, 2
    s_add_u32 s45, s45, s46
    s_add_u32 s45, s45, 4096
    v_add_u32 v140, s45, v12
    s_lshl_b32 s45, s7, 9
    v_add_u32 v12, s45, v12
    s_lshl_b32 s45, s8, 13
    s_add_u32 s45, s45, s44
    s_add_u32 s45, s45, 2048
    v_lshlrev_b32 v13, 4, v0
    v_add_u32 v13, s45, v13
    s_waitcnt vmcnt(20)
    v_lshlrev_b32 v116, 16, v96
    v_and_b32 v117, 0xffff0000, v96
    v_lshlrev_b32 v118, 16, v97
    v_and_b32 v119, 0xffff0000, v97
    v_lshlrev_b32 v120, 16, v98
    v_and_b32 v121, 0xffff0000, v98
    v_lshlrev_b32 v122, 16, v99
    v_and_b32 v123, 0xffff0000, v99
    v_lshlrev_b32 v124, 16, v100
    v_and_b32 v125, 0xffff0000, v100
    v_lshlrev_b32 v126, 16, v101
    v_and_b32 v127, 0xffff0000, v101
    v_lshlrev_b32 v128, 16, v102
    v_and_b32 v129, 0xffff0000, v102
    v_lshlrev_b32 v130, 16, v103
    v_and_b32 v131, 0xffff0000, v103
    v_lshlrev_b32 v132, 16, v104
    v_and_b32 v133, 0xffff0000, v104
    v_lshlrev_b32 v134, 16, v105
    v_and_b32 v135, 0xffff0000, v105
    v_add_f32 v8, v116, v117
    v_add_f32 v9, v118, v119
    v_add_f32 v8, v8, v120
    v_add_f32 v9, v9, v121
    v_add_f32 v8, v8, v122
    v_add_f32 v9, v9, v123
    v_add_f32 v8, v8, v124
    v_add_f32 v9, v9, v125
    v_add_f32 v8, v8, v126
    v_add_f32 v9, v9, v127
    v_add_f32 v8, v8, v128
    v_add_f32 v9, v9, v129
    v_add_f32 v8, v8, v130
    v_add_f32 v9, v9, v131
    v_add_f32 v8, v8, v132
    v_add_f32 v9, v9, v133
    v_add_f32 v8, v8, v134
    v_add_f32 v9, v9, v135
    v_add_f32 v8, v8, v9
    s_nop 1
    v_add_f32_dpp v8, v8, v8 quad_perm:[1,0,3,2] row_mask:0xf bank_mask:0xf
    s_nop 1
    v_add_f32_dpp v8, v8, v8 quad_perm:[2,3,0,1] row_mask:0xf bank_mask:0xf
    s_nop 1
    v_add_f32_dpp v8, v8, v8 row_half_mirror row_mask:0xf bank_mask:0xf
    v_mov_b32 v9, v8
    s_nop 1
    v_permlane16_swap_b32 v8, v9
    v_add_f32 v8, v8, v9
    v_mov_b32 v9, v8
    s_nop 1
    v_permlane32_swap_b32 v8, v9
    v_add_f32 v8, v8, v9
    v_mul_f32 v8, 0x3acccccd, v8
    v_mov_b32 v9, 0
    v_mov_b32 v10, 0
    v_sub_f32 v116, v116, v8
    v_sub_f32 v117, v117, v8
    v_fmac_f32 v9, v116, v116
    v_fmac_f32 v10, v117, v117
    v_sub_f32 v118, v118, v8
    v_sub_f32 v119, v119, v8
    v_fmac_f32 v9, v118, v118
    v_fmac_f32 v10, v119, v119
    v_sub_f32 v120, v120, v8
    v_sub_f32 v121, v121, v8
    v_fmac_f32 v9, v120, v120
    v_fmac_f32 v10, v121, v121
    v_sub_f32 v122, v122, v8
    v_sub_f32 v123, v123, v8
    v_fmac_f32 v9, v122, v122
    v_fmac_f32 v10, v123, v123
    v_sub_f32 v124, v124, v8
    v_sub_f32 v125, v125, v8
    v_fmac_f32 v9, v124, v124
    v_fmac_f32 v10, v125, v125
    v_sub_f32 v126, v126, v8
    v_sub_f32 v127, v127, v8
    v_fmac_f32 v9, v126, v126
    v_fmac_f32 v10, v127, v127
    v_sub_f32 v128, v128, v8
    v_sub_f32 v129, v129, v8
    v_fmac_f32 v9, v128, v128
    v_fmac_f32 v10, v129, v129
    v_sub_f32 v130, v130, v8
    v_sub_f32 v131, v131, v8
    v_fmac_f32 v9, v130, v130
    v_fmac_f32 v10, v131, v131
    v_sub_f32 v132, v132, v8
    v_sub_f32 v133, v133, v8
    v_fmac_f32 v9, v132, v132
    v_fmac_f32 v10, v133, v133
    v_sub_f32 v134, v134, v8
    v_sub_f32 v135, v135, v8
    v_fmac_f32 v9, v134, v134
    v_fmac_f32 v10, v135, v135
    v_add_f32 v9, v9, v10
    s_nop 1
    v_add_f32_dpp v9, v9, v9 quad_perm:[1,0,3,2] row_mask:0xf bank_mask:0xf
    s_nop 1
    v_add_f32_dpp v9, v9, v9 quad_perm:[2,3,0,1] row_mask:0xf bank_mask:0xf
    s_nop 1
    v_add_f32_dpp v9, v9, v9 row_half_mirror row_mask:0xf bank_mask:0xf
    v_mov_b32 v10, v9
    s_nop 1
    v_permlane16_swap_b32 v9, v10
    v_add_f32 v9, v9, v10
    v_mov_b32 v10, v9
    s_nop 1
    v_permlane32_swap_b32 v9, v10
    v_add_f32 v9, v9, v10
    v_mul_f32 v9, 0x3acccccd, v9
    v_cvt_pk_bf16_f32 v9, v8, v9
    v_lshlrev_b32 v8, 16, v9
    v_and_b32 v9, 0xffff0000, v9
    v_add_f32 v9, 0x3727c5ac, v9
    v_cvt_pk_bf16_f32 v9, v9, v9
    v_and_b32 v9, 0xffff0000, v9
    v_sqrt_f32 v9, v9
    s_nop 0
    v_cvt_pk_bf16_f32 v9, v9, v9
    v_and_b32 v9, 0xffff0000, v9
    v_rcp_f32 v9, v9
    s_waitcnt lgkmcnt(0)
    s_mul_i32 s11, s11, 0x9e3779b1
    s_add_u32 s11, s11, 0x7f4a7c15
    s_xor_b32 s55, s11, 0x5a5a5a5a
    s_and_b32 s12, s11, 0xff
    s_bfe_u32 s13, s11, 0x80008
    s_bfe_u32 s14, s11, 0x80010
    s_lshr_b32 s15, s11, 24
    s_and_b32 s96, s55, 0xff
    s_bfe_u32 s97, s55, 0x80008
    s_bfe_u32 s98, s55, 0x80010
    s_lshr_b32 s99, s55, 24
    v_lshlrev_b32 v10, 16, v106
    v_and_b32 v11, 0xffff0000, v106
    v_sub_f32 v10, v10, v8
    v_sub_f32 v11, v11, v8
    v_cvt_pk_bf16_f32 v10, v10, v11
    v_and_b32 v11, 0xffff0000, v10
    v_lshlrev_b32 v10, 16, v10
    v_mul_f32 v10, v10, v9
    v_mul_f32 v11, v11, v9
    v_cvt_pk_bf16_f32 v10, v10, v10
    v_cvt_pk_bf16_f32 v11, v11, v11
    v_and_b32 v96, v10, v3
    v_and_b32 v97, v10, v4
    v_and_b32 v98, v10, v5
    v_and_b32 v99, v10, v6
    v_and_b32 v100, v11, v3
    v_and_b32 v101, v11, v4
    v_and_b32 v102, v11, v5
    v_and_b32 v103, v11, v6
    s_waitcnt vmcnt(18)
    v_mfma_f32_16x16x32_bf16 v[136:139], v[96:99], v[16:19], 0
    v_mfma_f32_16x16x32_bf16 v[136:139], v[100:103], v[20:23], v[136:139]
    v_lshlrev_b32 v10, 16, v107
    v_and_b32 v11, 0xffff0000, v107
    v_sub_f32 v10, v10, v8
    v_sub_f32 v11, v11, v8
    v_cvt_pk_bf16_f32 v10, v10, v11
    v_and_b32 v11, 0xffff0000, v10
    v_lshlrev_b32 v10, 16, v10
    v_mul_f32 v10, v10, v9
    v_mul_f32 v11, v11, v9
    v_cvt_pk_bf16_f32 v10, v10, v10
    v_cvt_pk_bf16_f32 v11, v11, v11
    v_and_b32 v96, v10, v3
    v_and_b32 v97, v10, v4
    v_and_b32 v98, v10, v5
    v_and_b32 v99, v10, v6
    v_and_b32 v100, v11, v3
    v_and_b32 v101, v11, v4
    v_and_b32 v102, v11, v5
    v_and_b32 v103, v11, v6
    s_waitcnt vmcnt(16)
    v_mfma_f32_16x16x32_bf16 v[136:139], v[96:99], v[24:27], v[136:139]
    v_mfma_f32_16x16x32_bf16 v[136:139], v[100:103], v[28:31], v[136:139]
    v_lshlrev_b32 v10, 16, v108
    v_and_b32 v11, 0xffff0000, v108
    v_sub_f32 v10, v10, v8
    v_sub_f32 v11, v11, v8
    v_cvt_pk_bf16_f32 v10, v10, v11
    v_and_b32 v11, 0xffff0000, v10
    v_lshlrev_b32 v10, 16, v10
    v_mul_f32 v10, v10, v9
    v_mul_f32 v11, v11, v9
    v_cvt_pk_bf16_f32 v10, v10, v10
    v_cvt_pk_bf16_f32 v11, v11, v11
    v_and_b32 v96, v10, v3
    v_and_b32 v97, v10, v4
    v_and_b32 v98, v10, v5
    v_and_b32 v99, v10, v6
    v_and_b32 v100, v11, v3
    v_and_b32 v101, v11, v4
    v_and_b32 v102, v11, v5
    v_and_b32 v103, v11, v6
    s_waitcnt vmcnt(14)
    v_mfma_f32_16x16x32_bf16 v[136:139], v[96:99], v[32:35], v[136:139]
    v_mfma_f32_16x16x32_bf16 v[136:139], v[100:103], v[36:39], v[136:139]
    v_lshlrev_b32 v10, 16, v109
    v_and_b32 v11, 0xffff0000, v109
    v_sub_f32 v10, v10, v8
    v_sub_f32 v11, v11, v8
    v_cvt_pk_bf16_f32 v10, v10, v11
    v_and_b32 v11, 0xffff0000, v10
    v_lshlrev_b32 v10, 16, v10
    v_mul_f32 v10, v10, v9
    v_mul_f32 v11, v11, v9
    v_cvt_pk_bf16_f32 v10, v10, v10
    v_cvt_pk_bf16_f32 v11, v11, v11
    v_and_b32 v96, v10, v3
    v_and_b32 v97, v10, v4
    v_and_b32 v98, v10, v5
    v_and_b32 v99, v10, v6
    v_and_b32 v100, v11, v3
    v_and_b32 v101, v11, v4
    v_and_b32 v102, v11, v5
    v_and_b32 v103, v11, v6
    s_waitcnt vmcnt(12)
    v_mfma_f32_16x16x32_bf16 v[136:139], v[96:99], v[40:43], v[136:139]
    v_mfma_f32_16x16x32_bf16 v[136:139], v[100:103], v[44:47], v[136:139]
    v_lshlrev_b32 v10, 16, v110
    v_and_b32 v11, 0xffff0000, v110
    v_sub_f32 v10, v10, v8
    v_sub_f32 v11, v11, v8
    v_cvt_pk_bf16_f32 v10, v10, v11
    v_and_b32 v11, 0xffff0000, v10
    v_lshlrev_b32 v10, 16, v10
    v_mul_f32 v10, v10, v9
    v_mul_f32 v11, v11, v9
    v_cvt_pk_bf16_f32 v10, v10, v10
    v_cvt_pk_bf16_f32 v11, v11, v11
    v_and_b32 v96, v10, v3
    v_and_b32 v97, v10, v4
    v_and_b32 v98, v10, v5
    v_and_b32 v99, v10, v6
    v_and_b32 v100, v11, v3
    v_and_b32 v101, v11, v4
    v_and_b32 v102, v11, v5
    v_and_b32 v103, v11, v6
    s_waitcnt vmcnt(10)
    v_mfma_f32_16x16x32_bf16 v[136:139], v[96:99], v[48:51], v[136:139]
    v_mfma_f32_16x16x32_bf16 v[136:139], v[100:103], v[52:55], v[136:139]
    v_lshlrev_b32 v10, 16, v111
    v_and_b32 v11, 0xffff0000, v111
    v_sub_f32 v10, v10, v8
    v_sub_f32 v11, v11, v8
    v_cvt_pk_bf16_f32 v10, v10, v11
    v_and_b32 v11, 0xffff0000, v10
    v_lshlrev_b32 v10, 16, v10
    v_mul_f32 v10, v10, v9
    v_mul_f32 v11, v11, v9
    v_cvt_pk_bf16_f32 v10, v10, v10
    v_cvt_pk_bf16_f32 v11, v11, v11
    v_and_b32 v96, v10, v3
    v_and_b32 v97, v10, v4
    v_and_b32 v98, v10, v5
    v_and_b32 v99, v10, v6
    v_and_b32 v100, v11, v3
    v_and_b32 v101, v11, v4
    v_and_b32 v102, v11, v5
    v_and_b32 v103, v11, v6
    s_waitcnt vmcnt(8)
    v_mfma_f32_16x16x32_bf16 v[136:139], v[96:99], v[56:59], v[136:139]
    v_mfma_f32_16x16x32_bf16 v[136:139], v[100:103], v[60:63], v[136:139]
    v_lshlrev_b32 v10, 16, v112
    v_and_b32 v11, 0xffff0000, v112
    v_sub_f32 v10, v10, v8
    v_sub_f32 v11, v11, v8
    v_cvt_pk_bf16_f32 v10, v10, v11
    v_and_b32 v11, 0xffff0000, v10
    v_lshlrev_b32 v10, 16, v10
    v_mul_f32 v10, v10, v9
    v_mul_f32 v11, v11, v9
    v_cvt_pk_bf16_f32 v10, v10, v10
    v_cvt_pk_bf16_f32 v11, v11, v11
    v_and_b32 v96, v10, v3
    v_and_b32 v97, v10, v4
    v_and_b32 v98, v10, v5
    v_and_b32 v99, v10, v6
    v_and_b32 v100, v11, v3
    v_and_b32 v101, v11, v4
    v_and_b32 v102, v11, v5
    v_and_b32 v103, v11, v6
    s_waitcnt vmcnt(6)
    v_mfma_f32_16x16x32_bf16 v[136:139], v[96:99], v[64:67], v[136:139]
    v_mfma_f32_16x16x32_bf16 v[136:139], v[100:103], v[68:71], v[136:139]
    v_lshlrev_b32 v10, 16, v113
    v_and_b32 v11, 0xffff0000, v113
    v_sub_f32 v10, v10, v8
    v_sub_f32 v11, v11, v8
    v_cvt_pk_bf16_f32 v10, v10, v11
    v_and_b32 v11, 0xffff0000, v10
    v_lshlrev_b32 v10, 16, v10
    v_mul_f32 v10, v10, v9
    v_mul_f32 v11, v11, v9
    v_cvt_pk_bf16_f32 v10, v10, v10
    v_cvt_pk_bf16_f32 v11, v11, v11
    v_and_b32 v96, v10, v3
    v_and_b32 v97, v10, v4
    v_and_b32 v98, v10, v5
    v_and_b32 v99, v10, v6
    v_and_b32 v100, v11, v3
    v_and_b32 v101, v11, v4
    v_and_b32 v102, v11, v5
    v_and_b32 v103, v11, v6
    s_waitcnt vmcnt(4)
    v_mfma_f32_16x16x32_bf16 v[136:139], v[96:99], v[72:75], v[136:139]
    v_mfma_f32_16x16x32_bf16 v[136:139], v[100:103], v[76:79], v[136:139]
    v_lshlrev_b32 v10, 16, v114
    v_and_b32 v11, 0xffff0000, v114
    v_sub_f32 v10, v10, v8
    v_sub_f32 v11, v11, v8
    v_cvt_pk_bf16_f32 v10, v10, v11
    v_and_b32 v11, 0xffff0000, v10
    v_lshlrev_b32 v10, 16, v10
    v_mul_f32 v10, v10, v9
    v_mul_f32 v11, v11, v9
    v_cvt_pk_bf16_f32 v10, v10, v10
    v_cvt_pk_bf16_f32 v11, v11, v11
    v_and_b32 v96, v10, v3
    v_and_b32 v97, v10, v4
    v_and_b32 v98, v10, v5
    v_and_b32 v99, v10, v6
    v_and_b32 v100, v11, v3
    v_and_b32 v101, v11, v4
    v_and_b32 v102, v11, v5
    v_and_b32 v103, v11, v6
    s_waitcnt vmcnt(2)
    v_mfma_f32_16x16x32_bf16 v[136:139], v[96:99], v[80:83], v[136:139]
    v_mfma_f32_16x16x32_bf16 v[136:139], v[100:103], v[84:87], v[136:139]
    v_lshlrev_b32 v10, 16, v115
    v_and_b32 v11, 0xffff0000, v115
    v_sub_f32 v10, v10, v8
    v_sub_f32 v11, v11, v8
    v_cvt_pk_bf16_f32 v10, v10, v11
    v_and_b32 v11, 0xffff0000, v10
    v_lshlrev_b32 v10, 16, v10
    v_mul_f32 v10, v10, v9
    v_mul_f32 v11, v11, v9
    v_cvt_pk_bf16_f32 v10, v10, v10
    v_cvt_pk_bf16_f32 v11, v11, v11
    v_and_b32 v96, v10, v3
    v_and_b32 v97, v10, v4
    v_and_b32 v98, v10, v5
    v_and_b32 v99, v10, v6
    v_and_b32 v100, v11, v3
    v_and_b32 v101, v11, v4
    v_and_b32 v102, v11, v5
    v_and_b32 v103, v11, v6
    s_waitcnt vmcnt(0)
    v_mfma_f32_16x16x32_bf16 v[136:139], v[96:99], v[88:91], v[136:139]
    v_mfma_f32_16x16x32_bf16 v[136:139], v[100:103], v[92:95], v[136:139]
    s_nop 7
    global_store_dwordx4 v12, v[136:139], s[38:39]
    v_alignbit_b32 v145, v137, v137, 8
    v_alignbit_b32 v146, v138, v138, 16
    v_xor_b32 v145, v145, v136
    v_xor_b32 v145, v145, v146
    v_alignbit_b32 v146, v139, v139, 24
    v_xor_b32 v145, v145, v146
    v_xor_b32 v145, s11, v145
    global_store_dword v140, v145, s[38:39]
    global_load_dwordx2 v[44:45], v142, s[38:39] sc1
    s_memtime s[44:45]
    s_waitcnt lgkmcnt(0)
    s_load_dword s46, s[92:93], 0 glc
    s_waitcnt lgkmcnt(0)
    s_memtime s[48:49]
    s_waitcnt lgkmcnt(0)
    s_load_dword s46, s[92:93], 8192 glc
    s_waitcnt lgkmcnt(0)
    s_memtime s[50:51]
    s_waitcnt lgkmcnt(0)
    s_sub_u32 s44, s48, s44
    s_sub_u32 s45, s50, s48
    s_min_u32 s94, s94, s44
    s_min_u32 s95, s95, s45
    s_waitcnt vmcnt(0)
    v_cmp_ne_u32 s[48:49], s11, v44
    v_cmp_ne_u32 s[50:51], s54, v45
    s_or_b64 s[48:49], s[48:49], s[50:51]
    s_cselect_b32 s41, 1, 0
    s_cmp_lg_u32 s41, 0
    s_cbranch_scc1 L_nm_1
    ds_write_b32 v190, v190 offset:96
L_nm_1:
    s_mov_b32 s52, 100000
    s_mov_b32 s40, 0
L_q_2:
    global_load_dwordx4 v[16:19], v13, s[38:39] offset:-2048 sc1
    global_load_dwordx4 v[20:23], v13, s[38:39] offset:-1024 sc1
    global_load_dwordx4 v[24:27], v13, s[38:39] offset:0 sc1
    global_load_dwordx4 v[28:31], v13, s[38:39] offset:1024 sc1
    global_load_dwordx4 v[32:35], v13, s[38:39] offset:2048 sc1
    s_memtime s[44:45]
    s_waitcnt lgkmcnt(0)
    s_load_dword s46, s[92:93], 0 glc
    s_waitcnt lgkmcnt(0)
    s_memtime s[48:49]
    s_waitcnt lgkmcnt(0)
    s_load_dword s46, s[92:93], 8192 glc
    s_waitcnt lgkmcnt(0)
    s_memtime s[50:51]
    s_waitcnt lgkmcnt(0)
    s_sub_u32 s44, s48, s44
    s_sub_u32 s45, s50, s48
    s_min_u32 s94, s94, s44
    s_min_u32 s95, s95, s45
    s_waitcnt vmcnt(0)
    v_alignbit_b32 v40, v17, v17, 8
    v_alignbit_b32 v41, v18, v18, 16
    v_xor_b32 v40, v40, v16
    v_xor_b32 v40, v40, v41
    v_alignbit_b32 v41, v19, v19, 24
    v_xor_b32 v40, v40, v41
    v_xor_b32 v40, v40, v32
    v_sad_u8 v42, v40, s11, 0
    v_alignbit_b32 v40, v21, v21, 8
    v_alignbit_b32 v41, v22, v22, 16
    v_xor_b32 v40, v40, v20
    v_xor_b32 v40, v40, v41
    v_alignbit_b32 v41, v23, v23, 24
    v_xor_b32 v40, v40, v41
    v_xor_b32 v40, v40, v33
    v_sad_u8 v42, v40, s11, v42
    v_alignbit_b32 v40, v25, v25, 8
    v_alignbit_b32 v41, v26, v26, 16
    v_xor_b32 v40, v40, v24
    v_xor_b32 v40, v40, v41
    v_alignbit_b32 v41, v27, v27, 24
    v_xor_b32 v40, v40, v41
    v_xor_b32 v40, v40, v34
    v_sad_u8 v42, v40, s11, v42
    v_alignbit_b32 v40, v29, v29, 8
    v_alignbit_b32 v41, v30, v30, 16
    v_xor_b32 v40, v40, v28
    v_xor_b32 v40, v40, v41
    v_alignbit_b32 v41, v31, v31, 24
    v_xor_b32 v40, v40, v41
    v_xor_b32 v40, v40, v35
    v_sad_u8 v42, v40, s11, v42
    v_cmp_ne_u32 vcc, 0, v42
    s_cbranch_vccz L_qd_4
    s_and_b32 s44, s52, 3
    s_or_b32 s44, s44, s40
    s_cmp_lg_u32 s44, 1
    s_cbranch_scc1 L_qn_3
    global_load_dwordx2 v[16:17], v143, s[38:39] sc1
    s_waitcnt vmcnt(0)
    v_cmp_ne_u32 s[48:49], s11, v16
    v_cmp_ne_u32 s[50:51], s54, v17
    s_cmp_lg_u64 s[48:49], 0
    s_cbranch_scc1 L_qn_3
    s_cmp_eq_u64 s[50:51], 0
    s_cbranch_scc1 L_qn_3
    s_mov_b32 s40, 2
    v_add_u32 v12, 524288, v12
    v_add_u32 v13, 524288, v13
    v_add_u32 v140, 524288, v140
    global_store_dwordx4 v12, v[136:139], s[38:39] sc1
    global_store_dword v140, v145, s[38:39] sc1
L_qn_3:
    s_sub_u32 s52, s52, 1
    s_cmp_lg_u32 s52, 0
    s_cbranch_scc1 L_q_2
L_qd_4:
    v_add_f32 v8, v16, v20
    v_add_f32 v24, v24, v28
    v_add_f32 v9, v17, v21
    v_add_f32 v25, v25, v29
    v_add_f32 v10, v18, v22
    v_add_f32 v26, v26, v30
    v_add_f32 v11, v19, v23
    v_add_f32 v27, v27, v31
    v_add_f32 v8, v8, v24
    v_add_f32 v9, v9, v25
    v_add_f32 v10, v10, v26
    v_add_f32 v11, v11, v27
    v_mov_b32 v48, v8
    v_mov_b32 v49, v9
    v_mov_b32 v50, v10
    v_mov_b32 v51, v11
    v_permlane32_swap_b32 v8, v48
    v_permlane32_swap_b32 v9, v49
    v_permlane32_swap_b32 v10, v50
    v_permlane32_swap_b32 v11, v51
    v_add_f32 v8, v8, v48
    v_add_f32 v9, v9, v49
    v_add_f32 v10, v10, v50
    v_add_f32 v11, v11, v51
    v_cvt_pk_bf16_f32 v8, v8, v9
    v_cvt_pk_bf16_f32 v9, v10, v11
    v_and_b32 v10, 31, v0
    v_lshlrev_b32 v10, 3, v10
    ds_write_b64 v10, v[8:9] offset:128
    ds_write_b32 v190, v190 offset:0
    s_cmp_eq_u32 s41, 0
    s_cbranch_scc1 L_xq_5
    s_mov_b32 s52, 100000
L_poll_6:
    global_load_dwordx2 v[16:17], v142, s[38:39] sc1
    s_waitcnt vmcnt(0)
    v_sad_u8 v18, v16, s11, 0
    v_cmp_ne_u32 vcc, 0, v18
    s_cbranch_vccnz L_retry_7
L_pdone_8:
    v_cmp_ne_u32 s[50:51], s54, v17
    s_or_b64 s[50:51], s[50:51], vcc
    s_cselect_b32 s44, 1, 0
    v_mov_b32 v8, s44
    ds_write_b32 v190, v8 offset:96
    s_or_b32 s44, s44, s40
    s_cmp_lg_u32 s44, 1
    s_cbranch_scc1 L_xq_5
    v_add_u32 v12, 524288, v12
    v_add_u32 v140, 524288, v140
    global_store_dwordx4 v12, v[136:139], s[38:39] sc1
    global_store_dword v140, v145, s[38:39] sc1
L_xq_5:
    s_mov_b32 s52, 800000
L_poll_9:
    ds_read_b32 v8, v190 offset:96
    s_waitcnt lgkmcnt(0)
    v_lshrrev_b32 v9, 1, v8
    v_cmp_ne_u32 vcc, 0, v9
    s_cbranch_vccnz L_retry_10
L_pdone_11:
    v_readfirstlane_b32 s44, v8
    s_cmp_eq_u32 s44, 0
    s_cselect_b32 s43, 0, 2097152
    s_mul_i32 s42, s4, 163840
    s_add_u32 s42, s42, 2097152
    s_add_u32 s42, s42, s43
    v_lshlrev_b32 v150, 4, v0
    s_mul_i32 s44, s5, 640
    s_add_u32 s44, s44, s42
    v_add_u32 v151, s44, v150
    s_lshr_b32 s44, s100, 2
    s_lshl_b32 s44, s44, 14
    s_and_b32 s47, s100, 3
    s_lshl_b32 s47, s47, 11
    s_add_u32 s44, s44, s47
    s_add_u32 s44, s44, 1114112
    s_mov_b32 s56, s44
    s_cmp_lt_u32 s95, s94
    s_cselect_b32 s45, 8192, 0
    v_mov_b32 v8, s45
    ds_write_b32 v190, v8 offset:108
    s_add_u32 s44, s56, s45
    v_add_u32 v152, s44, v150
    s_lshr_b32 s44, s5, 2
    s_lshl_b32 s44, s44, 14
    s_and_b32 s47, s5, 3
    s_lshl_b32 s47, s47, 11
    s_add_u32 s44, s44, s47
    s_add_u32 s44, s44, 1114112
    s_lshl_b32 s45, s4, 8
    s_add_u32 s44, s44, s45
    v_lshlrev_b32 v153, 4, v1
    v_lshl_add_u32 v153, v2, 13, v153
    v_add_u32 v153, s44, v153
    v_and_b32 v8, 1, v1
    v_lshlrev_b32 v8, 7, v8
    v_lshrrev_b32 v154, 1, v1
    v_lshl_add_u32 v154, v154, 2, v8
    v_lshl_add_u32 v154, v2, 5, v154
    s_lshl_b32 s44, s100, 4
    s_add_u32 s44, s44, s42
    s_add_u32 s44, s44, 25344
    v_lshrrev_b32 v8, 1, v0
    v_min_u32 v8, 26, v8
    v_mul_u32_u24 v8, 5120, v8
    v_and_b32 v9, 1, v0
    v_lshl_add_u32 v8, v9, 9, v8
    v_add_u32 v155, s44, v8
    s_bfe_u32 s44, s100, 196608
    s_cmp_lg_u32 s44, s4
    s_cbranch_scc1 L_nt_12
    s_cmp_lt_u32 s5, 12
    s_cbranch_scc1 L_nt_12
    v_add_u32 v8, 131072, v152
    global_load_dwordx4 v[164:167], v8, s[38:39] sc1
    global_load_dwordx4 v[168:171], v8, s[38:39] offset:1024 sc1
L_nt_12:
    v_lshlrev_b32 v156, 3, v2
    v_lshrrev_b32 v156, v156, s11
    v_and_b32 v156, 0xff, v156
    v_lshlrev_b32 v14, 16, v14
    v_mov_b32 v30, s11
    v_mov_b32 v31, s11
    s_mov_b32 exec_hi, 1
    global_load_dwordx4 v[172:175], v151, s[38:39] sc1
    s_mov_b32 s52, 800000
L_poll_13:
    ds_read_b32 v8, v190 offset:12
    s_waitcnt lgkmcnt(0)
    v_cmp_ne_u32 vcc, 0, v8
    s_cbranch_vccnz L_retry_14
L_pdone_15:
    s_mov_b32 s52, 800000
L_poll_16:
    ds_read_b128 v[8:11], v190 offset:48
    ds_read_b128 v[32:35], v150 offset:384
    ds_read_b128 v[36:39], v150 offset:912
    ds_read_b128 v[40:43], v150 offset:1440
    ds_read_b128 v[44:47], v150 offset:1968
    s_waitcnt lgkmcnt(0)
    v_or3_b32 v8, v8, v9, v10
    v_or_b32 v8, v8, v11
    v_cmp_ne_u32 vcc, 0, v8
    s_cbranch_vccnz L_retry_17
L_pdone_18:
    v_pk_add_f32 v[32:33], v[32:33], v[36:37]
    v_pk_add_f32 v[34:35], v[34:35], v[38:39]
    v_pk_add_f32 v[40:41], v[40:41], v[44:45]
    v_pk_add_f32 v[42:43], v[42:43], v[46:47]
    v_pk_add_f32 v[8:9], v[32:33], v[40:41]
    v_pk_add_f32 v[10:11], v[34:35], v[42:43]
    v_and_or_b32 v8, v8, v7, s12
    v_and_or_b32 v9, v9, v7, s13
    v_and_or_b32 v10, v10, v7, s14
    v_and_or_b32 v11, v11, v7, s15
    s_cmp_lg_u32 s43, 0
    s_cbranch_scc1 L_sg_19
    global_store_dwordx4 v151, v[8:11], s[38:39] offset:0
L_sd_20:
    ds_write_b32 v190, v190 offset:104
    s_mov_b64 exec, -1
    s_cmp_ge_u32 s5, 20
    s_cbranch_scc1 L_noy_21
    s_mov_b32 s52, 800000
L_poll_23:
    ds_read_b128 v[36:39], v190 offset:112
    s_waitcnt lgkmcnt(0)
    v_or3_b32 v36, v36, v37, v38
    v_or_b32 v36, v36, v39
    v_cmp_ne_u32 vcc, 0, v36
    s_cbranch_vccnz L_retry_24
L_pdone_25:
    s_mov_b32 s52, 800000
L_poll_26:
    ds_read_b128 v[36:39], v190 offset:64
    ds_read_b128 v[32:35], v150 offset:4608
    s_waitcnt lgkmcnt(0)
    v_or3_b32 v36, v36, v37, v38
    v_or_b32 v36, v36, v39
    v_cmp_ne_u32 vcc, 0, v36
    s_cbranch_vccnz L_retry_27
L_pdone_28:
    v_permlane32_swap_b32 v32, v34
    v_permlane32_swap_b32 v33, v35
    v_add_f32 v32, v32, v34
    v_add_f32 v33, v33, v35
    s_nop 1
    v_permlane16_swap_b32 v32, v33
    v_add_f32 v32, v32, v33
    v_and_or_b32 v32, v32, v7, v156
    v_mov_b32 v33, v32
    s_nop 1
    v_permlane16_swap_b32 v32, v33
    v_mov_b32 v34, v32
    v_mov_b32 v35, v33
    s_nop 0
    v_permlane32_swap_b32 v32, v34
    v_permlane32_swap_b32 v33, v35
    s_mov_b32 exec_hi, 0
    global_store_dwordx4 v153, v[32:35], s[38:39] sc1
    s_mov_b64 exec, -1
L_noy_21:
    s_cmp_lt_u32 s5, 12
    s_cbranch_scc1 L_cend_22
    s_mov_b32 s52, 100000
L_poll_29:
    global_load_dwordx4 v[16:19], v152, s[38:39] sc1
    global_load_dwordx4 v[20:23], v152, s[38:39] offset:1024 sc1
    s_waitcnt vmcnt(0)
    v_xor_b32 v16, s12, v16
    v_xor_b32 v17, s13, v17
    v_xor_b32 v18, s14, v18
    v_xor_b32 v19, s15, v19
    v_or3_b32 v24, v16, v17, v18
    v_or_b32 v24, v24, v19
    v_xor_b32 v20, s12, v20
    v_xor_b32 v21, s13, v21
    v_xor_b32 v22, s14, v22
    v_xor_b32 v23, s15, v23
    v_or3_b32 v24, v24, v20, v21
    v_or3_b32 v24, v24, v22, v23
    v_and_b32 v24, 0xff, v24
    v_cmp_ne_u32 vcc, 0, v24
    s_cbranch_vccnz L_retry_30
L_pdone_31:
    v_pk_add_f32 v[16:17], v[16:17], v[20:21]
    v_pk_add_f32 v[18:19], v[18:19], v[22:23]
    s_nop 1
    v_permlane32_swap_b32 v16, v18
    v_permlane32_swap_b32 v17, v19
    v_add_f32 v16, v16, v18
    v_add_f32 v17, v17, v19
    s_nop 1
    v_permlane16_swap_b32 v16, v17
    v_add_f32 v16, v16, v17
    v_cvt_pk_bf16_f32 v16, v16, v16
    v_and_b32 v16, 0xffff0000, v16
    v_add_f32 v16, v16, v14
    v_cvt_pk_bf16_f32 v16, v16, v16
    ds_write_b32 v154, v16 offset:5632
    ds_write_b32 v190, v190 offset:80
    v_and_b32 v28, 0xffff0000, v16
    v_mul_f32 v29, v28, v28
    s_nop 0
    v_add_f32_dpp v28, v28, v28 quad_perm:[2,3,0,1] row_mask:0xf bank_mask:0xf
    v_add_f32_dpp v29, v29, v29 quad_perm:[2,3,0,1] row_mask:0xf bank_mask:0xf
    s_nop 0
    v_add_f32_dpp v28, v28, v28 row_ror:4 row_mask:0xf bank_mask:0xf
    v_add_f32_dpp v29, v29, v29 row_ror:4 row_mask:0xf bank_mask:0xf
    s_nop 0
    v_add_f32_dpp v28, v28, v28 row_ror:8 row_mask:0xf bank_mask:0xf
    v_add_f32_dpp v29, v29, v29 row_ror:8 row_mask:0xf bank_mask:0xf
    v_mov_b32 v17, v28
    v_mov_b32 v18, v29
    s_nop 0
    v_permlane16_swap_b32 v28, v17
    v_permlane16_swap_b32 v29, v18
    v_add_f32 v28, v28, v17
    v_add_f32 v29, v29, v18
    v_mov_b32 v17, v28
    v_mov_b32 v18, v29
    s_nop 0
    v_permlane32_swap_b32 v28, v17
    v_permlane32_swap_b32 v29, v18
    v_add_f32 v28, v28, v17
    v_add_f32 v29, v29, v18
    s_cmp_lg_u32 s43, 0
    s_cbranch_scc1 L_sg_32
    global_store_dwordx4 v155, v[28:31], s[38:39] offset:0
L_sd_33:
    s_cmp_lg_u32 s2, 96
    s_cbranch_scc1 L_cend_22
    s_mov_b64 exec, 1
    global_store_dword v190, v30, s[38:39] offset:0 sc1
L_cend_22:
    s_endpgm
L_retry_7:
    s_sleep 4
    s_sub_u32 s52, s52, 1
    s_cbranch_scc0 L_poll_6
    s_branch L_pdone_8
L_retry_10:
    s_sleep 1
    s_sub_u32 s52, s52, 1
    s_cbranch_scc0 L_poll_9
    s_branch L_pdone_11
L_retry_14:
    s_sleep 2
    s_sub_u32 s52, s52, 1
    s_cbranch_scc0 L_poll_13
    s_branch L_pdone_15
L_retry_17:
    s_sub_u32 s52, s52, 1
    s_cbranch_scc0 L_poll_16
    s_branch L_pdone_18
L_sg_19:
    s_nop 7
    global_store_dwordx4 v151, v[8:11], s[38:39] offset:0 sc1
    s_nop 1
    s_branch L_sd_20
L_retry_24:
    s_sleep 1
    s_sub_u32 s52, s52, 1
    s_cbranch_scc0 L_poll_23
    s_branch L_pdone_25
L_retry_27:
    s_sub_u32 s52, s52, 1
    s_cbranch_scc0 L_poll_26
    s_branch L_pdone_28
L_retry_30:
    s_sub_u32 s52, s52, 1
    s_cbranch_scc0 L_poll_29
    s_branch L_pdone_31
L_sg_32:
    s_nop 7
    global_store_dwordx4 v155, v[28:31], s[38:39] offset:0 sc1
    s_nop 1
    s_branch L_sd_33
L_att:
    s_load_dword s11, s[38:39], 0
    s_sub_u32 s100, s5, 12
    s_max_i32 s100, s100, 0
    s_add_u32 s101, s5, 12
    s_cmp_lt_u32 s5, 12
    s_cselect_b32 s101, s5, s101
    s_sub_u32 s44, s5, 8
    s_cmp_ge_u32 s5, 20
    s_cselect_b32 s101, s44, s101
    v_and_b32 v12, 7, v0
    v_and_b32 v13, 1, v12
    v_cmp_eq_u32 vcc, 1, v13
    v_mov_b32 v13, 0xffff
    v_mov_b32 v14, 0xffff0000
    v_cndmask_b32 v13, v13, v14, vcc
    v_lshrrev_b32 v12, 1, v12
    v_cmp_eq_u32 vcc, 0, v12
    s_nop 1
    v_cndmask_b32 v3, 0, v13, vcc
    v_cmp_eq_u32 vcc, 1, v12
    s_nop 1
    v_cndmask_b32 v4, 0, v13, vcc
    v_cmp_eq_u32 vcc, 2, v12
    s_nop 1
    v_cndmask_b32 v5, 0, v13, vcc
    v_cmp_eq_u32 vcc, 3, v12
    s_nop 1
    v_cndmask_b32 v6, 0, v13, vcc
    v_mov_b32 v7, 0xffffff00
    s_mov_b32 s53, 0x0c0c0400
    s_mov_b32 s58, 0xff00ff00
    s_mov_b32 s59, 0xff00ff00
    v_lshlrev_b32 v176, 4, v2
    v_and_b32 v177, 1, v2
    v_lshl_add_u32 v177, v1, 1, v177
    v_lshlrev_b32 v177, 4, v177
    v_lshrrev_b32 v12, 5, v0
    v_lshl_add_u32 v177, v12, 3, v177
    s_mul_i32 s44, s10, 528
    v_add_u32 v177, s44, v177
    v_mov_b32 v178, s44
    v_bfe_u32 v179, v0, 3, 1
    v_lshlrev_b32 v179, 7, v179
    v_lshl_add_u32 v179, v2, 5, v179
    s_lshl_b32 s44, s10, 9
    v_lshlrev_b32 v180, 3, v0
    v_add_u32 v180, s44, v180
    v_and_b32 v181, 1, v1
    v_lshlrev_b32 v181, 8, v181
    v_lshl_add_u32 v181, v2, 4, v181
    v_add_u32 v181, s44, v181
    v_lshrrev_b32 v12, 2, v1
    v_lshl_add_u32 v12, v2, 3, v12
    v_lshlrev_b32 v12, 6, v12
    s_lshl_b32 s44, s10, 13
    v_add_u32 v12, s44, v12
    v_and_b32 v13, 3, v1
    v_lshl_add_u32 v182, v13, 3, v12
    v_lshl_add_u32 v184, v2, 1, v1
    v_lshlrev_b32 v184, 4, v184
    s_lshl_b32 s44, s10, 8
    v_add_u32 v184, s44, v184
    v_lshlrev_b32 v185, 4, v0
    s_lshl_b32 s44, s10, 13
    s_add_u32 s44, s44, 49152
    v_add_u32 v186, s44, v185
    s_lshl_b32 s44, s10, 10
    s_add_u32 s44, s44, 81920
    v_add_u32 v187, s44, v185
    v_xor_b32 v12, v1, v2
    v_lshlrev_b32 v13, 8, v1
    v_add_u32 v13, s56, v13
    v_xor_b32 v192, 0, v12
    v_lshl_add_u32 v192, v192, 4, v13
    v_xor_b32 v193, 4, v12
    v_lshl_add_u32 v193, v193, 4, v13
    v_xor_b32 v194, 8, v12
    v_lshl_add_u32 v194, v194, 4, v13
    v_xor_b32 v195, 12, v12
    v_lshl_add_u32 v195, v195, 4, v13
    s_waitcnt vmcnt(3)
    s_add_u32 m0, s56, 4096
    s_nop 0
    global_load_lds_dwordx4 v8, s[18:19] nt
    v_add_u32 v8, s57, v8
    s_waitcnt vmcnt(3)
    s_add_u32 m0, s56, 5120
    s_nop 0
    global_load_lds_dwordx4 v9, s[18:19] nt
    v_add_u32 v9, s57, v9
    s_waitcnt vmcnt(3)
    s_add_u32 m0, s56, 6144
    s_nop 0
    global_load_lds_dwordx4 v10, s[18:19] nt
    v_add_u32 v10, s57, v10
    s_waitcnt vmcnt(3)
    s_add_u32 m0, s56, 7168
    s_nop 0
    global_load_lds_dwordx4 v11, s[18:19] nt
    v_add_u32 v11, s57, v11
    s_waitcnt vmcnt(3)
    s_add_u32 m0, s56, 8192
    s_nop 0
    global_load_lds_dwordx4 v8, s[18:19] nt
    v_add_u32 v8, 4096, v8
    s_waitcnt vmcnt(3)
    s_add_u32 m0, s56, 9216
    s_nop 0
    global_load_lds_dwordx4 v9, s[18:19] nt
    v_add_u32 v9, 4096, v9
    s_waitcnt vmcnt(3)
    s_add_u32 m0, s56, 10240
    s_nop 0
    global_load_lds_dwordx4 v10, s[18:19] nt
    v_add_u32 v10, 4096, v10
    s_waitcnt vmcnt(3)
    s_add_u32 m0, s56, 11264
    s_nop 0
    global_load_lds_dwordx4 v11, s[18:19] nt
    v_add_u32 v11, 4096, v11
    s_waitcnt vmcnt(3)
    s_add_u32 m0, s56, 12288
    s_nop 0
    global_load_lds_dwordx4 v8, s[18:19] nt
    s_add_u32 m0, s56, 13312
    s_nop 0
    global_load_lds_dwordx4 v9, s[18:19] nt
    s_add_u32 m0, s56, 14336
    s_nop 0
    global_load_lds_dwordx4 v10, s[18:19] nt
    s_add_u32 m0, s56, 15360
    s_nop 0
    global_load_lds_dwordx4 v11, s[18:19] nt
    ds_write_b32 v191, v190 offset:16
    s_waitcnt lgkmcnt(0)
    s_mul_i32 s11, s11, 0x9e3779b1
    s_add_u32 s11, s11, 0x7f4a7c15
    s_xor_b32 s55, s11, 0x5a5a5a5a
    s_and_b32 s12, s11, 0xff
    s_bfe_u32 s13, s11, 0x80008
    s_bfe_u32 s14, s11, 0x80010
    s_lshr_b32 s15, s11, 24
    s_and_b32 s96, s55, 0xff
    s_bfe_u32 s97, s55, 0x80008
    s_bfe_u32 s98, s55, 0x80010
    s_lshr_b32 s99, s55, 24
    s_mov_b32 s52, 800000
L_poll_34:
    ds_read_b32 v8, v190 offset:0
    s_waitcnt lgkmcnt(0)
    v_cmp_ne_u32 vcc, 0, v8
    s_cbranch_vccnz L_retry_35
L_pdone_36:
    ds_read_b128 v[144:147], v176 offset:128
    ds_read_b128 v[148:151], v176 offset:192
    ds_read_b128 v[152:155], v176 offset:256
    ds_read_b128 v[156:159], v176 offset:320
    s_waitcnt lgkmcnt(0)
    s_waitcnt vmcnt(12)
    ds_read_b128 v[16:19], v192 offset:0
    ds_read_b128 v[20:23], v193 offset:0
    ds_read_b128 v[24:27], v194 offset:0
    ds_read_b128 v[28:31], v195 offset:0
    s_waitcnt vmcnt(8)
    ds_read_b128 v[32:35], v192 offset:4096
    ds_read_b128 v[36:39], v193 offset:4096
    ds_read_b128 v[40:43], v194 offset:4096
    ds_read_b128 v[44:47], v195 offset:4096
    s_waitcnt lgkmcnt(4)
    v_mfma_f32_16x16x32_bf16 v[160:163], v[16:19], v[144:147], 0
    v_mfma_f32_16x16x32_bf16 v[160:163], v[20:23], v[148:151], v[160:163]
    v_mfma_f32_16x16x32_bf16 v[160:163], v[24:27], v[152:155], v[160:163]
    v_mfma_f32_16x16x32_bf16 v[160:163], v[28:31], v[156:159], v[160:163]
    s_waitcnt vmcnt(4)
    ds_read_b128 v[48:51], v192 offset:8192
    ds_read_b128 v[52:55], v193 offset:8192
    ds_read_b128 v[56:59], v194 offset:8192
    ds_read_b128 v[60:63], v195 offset:8192
    s_waitcnt lgkmcnt(4)
    v_mfma_f32_16x16x32_bf16 v[164:167], v[32:35], v[144:147], 0
    v_mfma_f32_16x16x32_bf16 v[164:167], v[36:39], v[148:151], v[164:167]
    v_mfma_f32_16x16x32_bf16 v[164:167], v[40:43], v[152:155], v[164:167]
    v_mfma_f32_16x16x32_bf16 v[164:167], v[44:47], v[156:159], v[164:167]
    s_waitcnt vmcnt(0)
    ds_read_b128 v[64:67], v192 offset:12288
    ds_read_b128 v[68:71], v193 offset:12288
    ds_read_b128 v[72:75], v194 offset:12288
    ds_read_b128 v[76:79], v195 offset:12288
    s_waitcnt lgkmcnt(4)
    v_mfma_f32_16x16x32_bf16 v[168:171], v[48:51], v[144:147], 0
    v_mfma_f32_16x16x32_bf16 v[168:171], v[52:55], v[148:151], v[168:171]
    v_mfma_f32_16x16x32_bf16 v[168:171], v[56:59], v[152:155], v[168:171]
    v_mfma_f32_16x16x32_bf16 v[168:171], v[60:63], v[156:159], v[168:171]
    s_waitcnt lgkmcnt(0)
    v_mfma_f32_16x16x32_bf16 v[172:175], v[64:67], v[144:147], 0
    v_mfma_f32_16x16x32_bf16 v[172:175], v[68:71], v[148:151], v[172:175]
    v_mfma_f32_16x16x32_bf16 v[172:175], v[72:75], v[152:155], v[172:175]
    v_mfma_f32_16x16x32_bf16 v[172:175], v[76:79], v[156:159], v[172:175]
    v_cvt_pk_bf16_f32 v8, v160, v161
    v_and_b32 v9, 0xffff0000, v8
    v_lshlrev_b32 v8, 16, v8
    v_mul_f32 v8, 0x3db504f3, v8
    v_mul_f32 v9, 0x3db504f3, v9
    v_cvt_pk_bf16_f32 v8, v8, v9
    v_and_b32 v161, 0xffff0000, v8
    v_lshlrev_b32 v160, 16, v8
    v_cvt_pk_bf16_f32 v8, v162, v163
    v_and_b32 v9, 0xffff0000, v8
    v_lshlrev_b32 v8, 16, v8
    v_mul_f32 v8, 0x3db504f3, v8
    v_mul_f32 v9, 0x3db504f3, v9
    v_cvt_pk_bf16_f32 v8, v8, v9
    v_and_b32 v163, 0xffff0000, v8
    v_lshlrev_b32 v162, 16, v8
    v_cvt_pk_bf16_f32 v8, v164, v165
    v_and_b32 v9, 0xffff0000, v8
    v_lshlrev_b32 v8, 16, v8
    v_mul_f32 v8, 0x3db504f3, v8
    v_mul_f32 v9, 0x3db504f3, v9
    v_cvt_pk_bf16_f32 v8, v8, v9
    v_and_b32 v165, 0xffff0000, v8
    v_lshlrev_b32 v164, 16, v8
    v_cvt_pk_bf16_f32 v8, v166, v167
    v_and_b32 v9, 0xffff0000, v8
    v_lshlrev_b32 v8, 16, v8
    v_mul_f32 v8, 0x3db504f3, v8
    v_mul_f32 v9, 0x3db504f3, v9
    v_cvt_pk_bf16_f32 v8, v8, v9
    v_and_b32 v167, 0xffff0000, v8
    v_lshlrev_b32 v166, 16, v8
    v_cvt_pk_bf16_f32 v8, v168, v169
    v_and_b32 v9, 0xffff0000, v8
    v_lshlrev_b32 v8, 16, v8
    v_mul_f32 v8, 0x3db504f3, v8
    v_mul_f32 v9, 0x3db504f3, v9
    v_cvt_pk_bf16_f32 v8, v8, v9
    v_and_b32 v169, 0xffff0000, v8
    v_lshlrev_b32 v168, 16, v8
    v_cvt_pk_bf16_f32 v8, v170, v171
    v_and_b32 v9, 0xffff0000, v8
    v_lshlrev_b32 v8, 16, v8
    v_mul_f32 v8, 0x3db504f3, v8
    v_mul_f32 v9, 0x3db504f3, v9
    v_cvt_pk_bf16_f32 v8, v8, v9
    v_and_b32 v171, 0xffff0000, v8
    v_lshlrev_b32 v170, 16, v8
    v_cvt_pk_bf16_f32 v8, v172, v173
    v_and_b32 v9, 0xffff0000, v8
    v_lshlrev_b32 v8, 16, v8
    v_mul_f32 v8, 0x3db504f3, v8
    v_mul_f32 v9, 0x3db504f3, v9
    v_cvt_pk_bf16_f32 v8, v8, v9
    v_and_b32 v173, 0xffff0000, v8
    v_lshlrev_b32 v172, 16, v8
    v_cvt_pk_bf16_f32 v8, v174, v175
    v_and_b32 v9, 0xffff0000, v8
    v_lshlrev_b32 v8, 16, v8
    v_mul_f32 v8, 0x3db504f3, v8
    v_mul_f32 v9, 0x3db504f3, v9
    v_cvt_pk_bf16_f32 v8, v8, v9
    v_and_b32 v175, 0xffff0000, v8
    v_lshlrev_b32 v174, 16, v8
    v_max3_f32 v8, v160, v161, v162
    v_max3_f32 v9, v163, v164, v165
    v_max3_f32 v8, v8, v166, v167
    v_max3_f32 v9, v9, v168, v169
    v_max3_f32 v8, v8, v170, v171
    v_max3_f32 v9, v9, v172, v173
    v_max3_f32 v8, v8, v174, v175
    v_max_f32 v8, v8, v9
    v_mov_b32 v9, v8
    s_nop 1
    v_permlane16_swap_b32 v8, v9
    v_max_f32 v8, v8, v9
    v_mov_b32 v9, v8
    s_nop 1
    v_permlane32_swap_b32 v8, v9
    v_max_f32 v8, v8, v9
    ds_write_b32 v191, v8 offset:32
    s_mov_b32 s52, 800000
L_poll_37:
    ds_read_b128 v[16:19], v190 offset:32
    s_waitcnt lgkmcnt(0)
    v_or3_b32 v8, v16, v17, v18
    v_or_b32 v8, v8, v19
    v_and_b32 v8, 1, v8
    v_cmp_ne_u32 vcc, 0, v8
    s_cbranch_vccnz L_retry_38
L_pdone_39:
    v_max3_f32 v8, v16, v17, v18
    v_max_f32 v8, v8, v19
    v_sub_f32 v160, v160, v8
    v_sub_f32 v161, v161, v8
    v_sub_f32 v162, v162, v8
    v_sub_f32 v163, v163, v8
    v_sub_f32 v164, v164, v8
    v_sub_f32 v165, v165, v8
    v_sub_f32 v166, v166, v8
    v_sub_f32 v167, v167, v8
    v_sub_f32 v168, v168, v8
    v_sub_f32 v169, v169, v8
    v_sub_f32 v170, v170, v8
    v_sub_f32 v171, v171, v8
    v_sub_f32 v172, v172, v8
    v_sub_f32 v173, v173, v8
    v_sub_f32 v174, v174, v8
    v_sub_f32 v175, v175, v8
    v_mul_f32 v160, 0x3fb8aa3b, v160
    v_mul_f32 v161, 0x3fb8aa3b, v161
    v_mul_f32 v162, 0x3fb8aa3b, v162
    v_mul_f32 v163, 0x3fb8aa3b, v163
    v_mul_f32 v164, 0x3fb8aa3b, v164
    v_mul_f32 v165, 0x3fb8aa3b, v165
    v_mul_f32 v166, 0x3fb8aa3b, v166
    v_mul_f32 v167, 0x3fb8aa3b, v167
    v_mul_f32 v168, 0x3fb8aa3b, v168
    v_mul_f32 v169, 0x3fb8aa3b, v169
    v_mul_f32 v170, 0x3fb8aa3b, v170
    v_mul_f32 v171, 0x3fb8aa3b, v171
    v_mul_f32 v172, 0x3fb8aa3b, v172
    v_mul_f32 v173, 0x3fb8aa3b, v173
    v_mul_f32 v174, 0x3fb8aa3b, v174
    v_mul_f32 v175, 0x3fb8aa3b, v175
    v_exp_f32 v160, v160
    v_exp_f32 v161, v161
    v_exp_f32 v162, v162
    v_exp_f32 v163, v163
    v_exp_f32 v164, v164
    v_exp_f32 v165, v165
    v_exp_f32 v166, v166
    v_exp_f32 v167, v167
    v_exp_f32 v168, v168
    v_exp_f32 v169, v169
    v_exp_f32 v170, v170
    v_exp_f32 v171, v171
    v_exp_f32 v172, v172
    v_exp_f32 v173, v173
    v_exp_f32 v174, v174
    v_exp_f32 v175, v175
    v_add_f32 v9, v160, v161
    v_add_f32 v10, v162, v163
    v_add_f32 v9, v9, v164
    v_add_f32 v10, v10, v165
    v_add_f32 v9, v9, v166
    v_add_f32 v10, v10, v167
    v_add_f32 v9, v9, v168
    v_add_f32 v10, v10, v169
    v_add_f32 v9, v9, v170
    v_add_f32 v10, v10, v171
    v_add_f32 v9, v9, v172
    v_add_f32 v10, v10, v173
    v_add_f32 v9, v9, v174
    v_add_f32 v10, v10, v175
    v_add_f32 v9, v9, v10
    v_mov_b32 v10, v9
    s_nop 1
    v_permlane16_swap_b32 v9, v10
    v_add_f32 v9, v9, v10
    v_mov_b32 v10, v9
    s_nop 1
    v_permlane32_swap_b32 v9, v10
    v_add_f32 v9, v9, v10
    v_mul_f32 v8, 0x3e800000, v8
    v_mov_b32 v10, 0
    v_mov_b32 v11, 0
    s_mov_b64 exec, 1
    ds_write_b128 v178, v[8:11] offset:896
    s_mov_b64 exec, -1
    v_cvt_pk_bf16_f32 v12, v160, v160
    v_and_b32 v12, 0xffff0000, v12
    v_sub_f32 v12, v160, v12
    v_cndmask_b32 v12, v160, v12, s[58:59]
    v_cvt_pk_bf16_f32 v12, v12, v12
    v_and_b32 v16, v12, v3
    v_and_b32 v17, v12, v4
    v_and_b32 v18, v12, v5
    v_and_b32 v19, v12, v6
    v_cvt_pk_bf16_f32 v12, v161, v161
    v_and_b32 v12, 0xffff0000, v12
    v_sub_f32 v12, v161, v12
    v_cndmask_b32 v12, v161, v12, s[58:59]
    v_cvt_pk_bf16_f32 v12, v12, v12
    v_and_b32 v20, v12, v3
    v_and_b32 v21, v12, v4
    v_and_b32 v22, v12, v5
    v_and_b32 v23, v12, v6
    v_cvt_pk_bf16_f32 v12, v162, v162
    v_and_b32 v12, 0xffff0000, v12
    v_sub_f32 v12, v162, v12
    v_cndmask_b32 v12, v162, v12, s[58:59]
    v_cvt_pk_bf16_f32 v12, v12, v12
    v_and_b32 v24, v12, v3
    v_and_b32 v25, v12, v4
    v_and_b32 v26, v12, v5
    v_and_b32 v27, v12, v6
    v_cvt_pk_bf16_f32 v12, v163, v163
    v_and_b32 v12, 0xffff0000, v12
    v_sub_f32 v12, v163, v12
    v_cndmask_b32 v12, v163, v12, s[58:59]
    v_cvt_pk_bf16_f32 v12, v12, v12
    v_and_b32 v28, v12, v3
    v_and_b32 v29, v12, v4
    v_and_b32 v30, v12, v5
    v_and_b32 v31, v12, v6
    v_cvt_pk_bf16_f32 v12, v164, v164
    v_and_b32 v12, 0xffff0000, v12
    v_sub_f32 v12, v164, v12
    v_cndmask_b32 v12, v164, v12, s[58:59]
    v_cvt_pk_bf16_f32 v12, v12, v12
    v_and_b32 v32, v12, v3
    v_and_b32 v33, v12, v4
    v_and_b32 v34, v12, v5
    v_and_b32 v35, v12, v6
    v_cvt_pk_bf16_f32 v12, v165, v165
    v_and_b32 v12, 0xffff0000, v12
    v_sub_f32 v12, v165, v12
    v_cndmask_b32 v12, v165, v12, s[58:59]
    v_cvt_pk_bf16_f32 v12, v12, v12
    v_and_b32 v36, v12, v3
    v_and_b32 v37, v12, v4
    v_and_b32 v38, v12, v5
    v_and_b32 v39, v12, v6
    v_cvt_pk_bf16_f32 v12, v166, v166
    v_and_b32 v12, 0xffff0000, v12
    v_sub_f32 v12, v166, v12
    v_cndmask_b32 v12, v166, v12, s[58:59]
    v_cvt_pk_bf16_f32 v12, v12, v12
    v_and_b32 v40, v12, v3
    v_and_b32 v41, v12, v4
    v_and_b32 v42, v12, v5
    v_and_b32 v43, v12, v6
    v_cvt_pk_bf16_f32 v12, v167, v167
    v_and_b32 v12, 0xffff0000, v12
    v_sub_f32 v12, v167, v12
    v_cndmask_b32 v12, v167, v12, s[58:59]
    v_cvt_pk_bf16_f32 v12, v12, v12
    v_and_b32 v44, v12, v3
    v_and_b32 v45, v12, v4
    v_and_b32 v46, v12, v5
    v_and_b32 v47, v12, v6
    v_cvt_pk_bf16_f32 v12, v168, v168
    v_and_b32 v12, 0xffff0000, v12
    v_sub_f32 v12, v168, v12
    v_cndmask_b32 v12, v168, v12, s[58:59]
    v_cvt_pk_bf16_f32 v12, v12, v12
    v_and_b32 v48, v12, v3
    v_and_b32 v49, v12, v4
    v_and_b32 v50, v12, v5
    v_and_b32 v51, v12, v6
    v_cvt_pk_bf16_f32 v12, v169, v169
    v_and_b32 v12, 0xffff0000, v12
    v_sub_f32 v12, v169, v12
    v_cndmask_b32 v12, v169, v12, s[58:59]
    v_cvt_pk_bf16_f32 v12, v12, v12
    v_and_b32 v52, v12, v3
    v_and_b32 v53, v12, v4
    v_and_b32 v54, v12, v5
    v_and_b32 v55, v12, v6
    v_cvt_pk_bf16_f32 v12, v170, v170
    v_and_b32 v12, 0xffff0000, v12
    v_sub_f32 v12, v170, v12
    v_cndmask_b32 v12, v170, v12, s[58:59]
    v_cvt_pk_bf16_f32 v12, v12, v12
    v_and_b32 v56, v12, v3
    v_and_b32 v57, v12, v4
    v_and_b32 v58, v12, v5
    v_and_b32 v59, v12, v6
    v_cvt_pk_bf16_f32 v12, v171, v171
    v_and_b32 v12, 0xffff0000, v12
    v_sub_f32 v12, v171, v12
    v_cndmask_b32 v12, v171, v12, s[58:59]
    v_cvt_pk_bf16_f32 v12, v12, v12
    v_and_b32 v60, v12, v3
    v_and_b32 v61, v12, v4
    v_and_b32 v62, v12, v5
    v_and_b32 v63, v12, v6
    v_cvt_pk_bf16_f32 v12, v172, v172
    v_and_b32 v12, 0xffff0000, v12
    v_sub_f32 v12, v172, v12
    v_cndmask_b32 v12, v172, v12, s[58:59]
    v_cvt_pk_bf16_f32 v12, v12, v12
    v_and_b32 v64, v12, v3
    v_and_b32 v65, v12, v4
    v_and_b32 v66, v12, v5
    v_and_b32 v67, v12, v6
    v_cvt_pk_bf16_f32 v12, v173, v173
    v_and_b32 v12, 0xffff0000, v12
    v_sub_f32 v12, v173, v12
    v_cndmask_b32 v12, v173, v12, s[58:59]
    v_cvt_pk_bf16_f32 v12, v12, v12
    v_and_b32 v68, v12, v3
    v_and_b32 v69, v12, v4
    v_and_b32 v70, v12, v5
    v_and_b32 v71, v12, v6
    v_cvt_pk_bf16_f32 v12, v174, v174
    v_and_b32 v12, 0xffff0000, v12
    v_sub_f32 v12, v174, v12
    v_cndmask_b32 v12, v174, v12, s[58:59]
    v_cvt_pk_bf16_f32 v12, v12, v12
    v_and_b32 v72, v12, v3
    v_and_b32 v73, v12, v4
    v_and_b32 v74, v12, v5
    v_and_b32 v75, v12, v6
    v_cvt_pk_bf16_f32 v12, v175, v175
    v_and_b32 v12, 0xffff0000, v12
    v_sub_f32 v12, v175, v12
    v_cndmask_b32 v12, v175, v12, s[58:59]
    v_cvt_pk_bf16_f32 v12, v12, v12
    v_and_b32 v76, v12, v3
    v_and_b32 v77, v12, v4
    v_and_b32 v78, v12, v5
    v_and_b32 v79, v12, v6
    s_mov_b32 s52, 800000
L_poll_40:
    ds_read_b32 v8, v190 offset:4
    s_waitcnt lgkmcnt(0)
    v_cmp_ne_u32 vcc, 0, v8
    s_cbranch_vccnz L_retry_41
L_pdone_42:
    ds_read_b128 v[80:83], v187 offset:0
    ds_read_b128 v[84:87], v187 offset:4096
    ds_read_b128 v[88:91], v187 offset:8192
    ds_read_b128 v[92:95], v187 offset:12288
    ds_read_b128 v[96:99], v187 offset:16384
    ds_read_b128 v[100:103], v187 offset:20480
    s_waitcnt lgkmcnt(0)
    v_mfma_f32_16x16x32_bf16 v[144:147], v[16:19], v[80:83], 0
    v_mfma_f32_16x16x32_bf16 v[144:147], v[20:23], v[84:87], v[144:147]
    v_mfma_f32_16x16x32_bf16 v[144:147], v[24:27], v[88:91], v[144:147]
    v_mfma_f32_16x16x32_bf16 v[144:147], v[28:31], v[92:95], v[144:147]
    v_mfma_f32_16x16x32_bf16 v[144:147], v[32:35], v[96:99], v[144:147]
    v_mfma_f32_16x16x32_bf16 v[144:147], v[36:39], v[100:103], v[144:147]
    s_mov_b32 s52, 800000
L_poll_43:
    ds_read_b32 v8, v190 offset:8
    s_waitcnt lgkmcnt(0)
    v_cmp_ne_u32 vcc, 0, v8
    s_cbranch_vccnz L_retry_44
L_pdone_45:
    ds_read_b128 v[104:107], v187 offset:24576
    ds_read_b128 v[108:111], v187 offset:28672
    ds_read_b128 v[112:115], v187 offset:32768
    ds_read_b128 v[116:119], v187 offset:36864
    ds_read_b128 v[120:123], v187 offset:40960
    ds_read_b128 v[124:127], v187 offset:45056
    s_waitcnt lgkmcnt(0)
    v_mfma_f32_16x16x32_bf16 v[144:147], v[40:43], v[104:107], v[144:147]
    v_mfma_f32_16x16x32_bf16 v[144:147], v[44:47], v[108:111], v[144:147]
    v_mfma_f32_16x16x32_bf16 v[144:147], v[48:51], v[112:115], v[144:147]
    v_mfma_f32_16x16x32_bf16 v[144:147], v[52:55], v[116:119], v[144:147]
    v_mfma_f32_16x16x32_bf16 v[144:147], v[56:59], v[120:123], v[144:147]
    v_mfma_f32_16x16x32_bf16 v[144:147], v[60:63], v[124:127], v[144:147]
    s_mov_b32 s52, 800000
L_poll_46:
    ds_read_b32 v8, v190 offset:96
    s_waitcnt lgkmcnt(0)
    v_lshrrev_b32 v9, 1, v8
    v_cmp_ne_u32 vcc, 0, v9
    s_cbranch_vccnz L_retry_47
L_pdone_48:
    v_readfirstlane_b32 s44, v8
    s_cmp_eq_u32 s44, 0
    s_cselect_b32 s43, 0, 2097152
    s_mul_i32 s42, s4, 163840
    s_add_u32 s42, s42, 2097152
    s_add_u32 s42, s42, s43
    s_mul_i32 s44, s10, 640
    s_add_u32 s44, s44, s42
    s_add_u32 s44, s44, 3840
    v_lshrrev_b32 v8, 5, v0
    v_mul_u32_u24 v8, 10240, v8
    v_add_u32 v8, s44, v8
    v_and_b32 v9, 31, v0
    v_lshl_add_u32 v12, v9, 4, v8
    v_and_b32 v9, 3, v0
    v_mul_u32_u24 v9, 2560, v9
    v_add_u32 v13, v9, v8
    s_mov_b32 s52, 800000
L_poll_49:
    ds_read_b32 v8, v190 offset:12
    s_waitcnt lgkmcnt(0)
    v_cmp_ne_u32 vcc, 0, v8
    s_cbranch_vccnz L_retry_50
L_pdone_51:
    ds_read_b128 v[128:131], v187 offset:49152
    ds_read_b128 v[132:135], v187 offset:53248
    ds_read_b128 v[136:139], v187 offset:57344
    s_waitcnt lgkmcnt(0)
    v_mfma_f32_16x16x32_bf16 v[144:147], v[64:67], v[128:131], v[144:147]
    v_mfma_f32_16x16x32_bf16 v[144:147], v[68:71], v[132:135], v[144:147]
    v_mfma_f32_16x16x32_bf16 v[144:147], v[72:75], v[136:139], v[144:147]
    s_mov_b32 s52, 800000
L_poll_52:
    ds_read_b32 v8, v190 offset:100
    ds_read_b128 v[140:143], v187 offset:61440
    s_waitcnt lgkmcnt(0)
    v_cmp_ne_u32 vcc, 0, v8
    s_cbranch_vccnz L_retry_53
L_pdone_54:
    v_mfma_f32_16x16x32_bf16 v[144:147], v[76:79], v[140:143], v[144:147]
    s_nop 7
    v_permlane32_swap_b32 v144, v146
    v_permlane32_swap_b32 v145, v147
    v_add_f32 v144, v144, v146
    v_add_f32 v145, v145, v147
    ds_write_b64 v177, v[144:145] offset:384
    ds_write_b32 v191, v190 offset:48
    s_cmp_ge_u32 s5, 20
    s_cbranch_scc1 L_anow_55
    s_mov_b32 s52, 100000
L_poll_57:
    global_load_dwordx4 v[120:123], v13, s[38:39] offset:-3328 sc1
    global_load_dwordx4 v[104:107], v12, s[38:39] offset:-3840 sc1
    global_load_dwordx4 v[108:111], v12, s[38:39] offset:-1280 sc1
    global_load_dwordx4 v[112:115], v12, s[38:39] offset:1280 sc1
    global_load_dwordx4 v[116:119], v12, s[38:39] offset:3840 sc1
    s_waitcnt vmcnt(0)
    v_xor_b32 v104, s12, v104
    v_xor_b32 v105, s13, v105
    v_xor_b32 v106, s14, v106
    v_xor_b32 v107, s15, v107
    v_or3_b32 v40, v104, v105, v106
    v_or_b32 v40, v40, v107
    v_xor_b32 v108, s12, v108
    v_xor_b32 v109, s13, v109
    v_xor_b32 v110, s14, v110
    v_xor_b32 v111, s15, v111
    v_or3_b32 v40, v40, v108, v109
    v_or3_b32 v40, v40, v110, v111
    v_xor_b32 v112, s12, v112
    v_xor_b32 v113, s13, v113
    v_xor_b32 v114, s14, v114
    v_xor_b32 v115, s15, v115
    v_or3_b32 v40, v40, v112, v113
    v_or3_b32 v40, v40, v114, v115
    v_xor_b32 v116, s12, v116
    v_xor_b32 v117, s13, v117
    v_xor_b32 v118, s14, v118
    v_xor_b32 v119, s15, v119
    v_or3_b32 v40, v40, v116, v117
    v_or3_b32 v40, v40, v118, v119
    v_xor_b32 v120, s12, v120
    v_xor_b32 v121, s13, v121
    v_xor_b32 v122, s14, v122
    v_xor_b32 v123, s15, v123
    v_or3_b32 v40, v40, v120, v121
    v_or3_b32 v40, v40, v122, v123
    v_and_b32 v40, 0xff, v40
    v_cmp_ne_u32 vcc, 0, v40
    s_cbranch_vccnz L_retry_58
L_pdone_59:
    ds_write_b32 v191, v190 offset:112
    ds_read_b32 v42, v190 offset:84
    ds_read_b64_tr_b16 v[64:65], v182 offset:16384
    ds_read_b64_tr_b16 v[80:81], v182 offset:16416
    ds_read_b64_tr_b16 v[66:67], v182 offset:16640
    ds_read_b64_tr_b16 v[82:83], v182 offset:16672
    ds_read_b64_tr_b16 v[68:69], v182 offset:18432
    ds_read_b64_tr_b16 v[84:85], v182 offset:18464
    ds_read_b64_tr_b16 v[70:71], v182 offset:18688
    ds_read_b64_tr_b16 v[86:87], v182 offset:18720
    ds_read_b64_tr_b16 v[72:73], v182 offset:20480
    ds_read_b64_tr_b16 v[88:89], v182 offset:20512
    ds_read_b64_tr_b16 v[74:75], v182 offset:20736
    ds_read_b64_tr_b16 v[90:91], v182 offset:20768
    ds_read_b64_tr_b16 v[76:77], v182 offset:22528
    ds_read_b64_tr_b16 v[92:93], v182 offset:22560
    ds_read_b64_tr_b16 v[78:79], v182 offset:22784
    ds_read_b64_tr_b16 v[94:95], v182 offset:22816
    v_max_f32_dpp v41, v120, v120 quad_perm:[1,0,3,2] row_mask:0xf bank_mask:0xf
    s_nop 1
    v_max_f32_dpp v41, v41, v41 quad_perm:[2,3,0,1] row_mask:0xf bank_mask:0xf
    v_sub_f32 v40, v120, v41
    v_mul_f32 v40, 0x3fb8aa3b, v40
    v_exp_f32 v40, v40
    s_nop 0
    v_mul_f32 v41, v40, v121
    s_nop 1
    v_add_f32_dpp v41, v41, v41 quad_perm:[1,0,3,2] row_mask:0xf bank_mask:0xf
    s_nop 1
    v_add_f32_dpp v41, v41, v41 quad_perm:[2,3,0,1] row_mask:0xf bank_mask:0xf
    v_rcp_f32 v41, v41
    s_nop 0
    v_mul_f32 v40, v40, v41
    s_nop 1
    v_mul_f32_dpp v8, v40, v104 quad_perm:[0,0,0,0] row_mask:0xf bank_mask:0xf
    v_mul_f32_dpp v9, v40, v105 quad_perm:[0,0,0,0] row_mask:0xf bank_mask:0xf
    v_mul_f32_dpp v10, v40, v106 quad_perm:[0,0,0,0] row_mask:0xf bank_mask:0xf
    v_mul_f32_dpp v11, v40, v107 quad_perm:[0,0,0,0] row_mask:0xf bank_mask:0xf
    v_fmac_f32_dpp v8, v40, v108 quad_perm:[1,1,1,1] row_mask:0xf bank_mask:0xf
    v_fmac_f32_dpp v9, v40, v109 quad_perm:[1,1,1,1] row_mask:0xf bank_mask:0xf
    v_fmac_f32_dpp v10, v40, v110 quad_perm:[1,1,1,1] row_mask:0xf bank_mask:0xf
    v_fmac_f32_dpp v11, v40, v111 quad_perm:[1,1,1,1] row_mask:0xf bank_mask:0xf
    v_fmac_f32_dpp v8, v40, v112 quad_perm:[2,2,2,2] row_mask:0xf bank_mask:0xf
    v_fmac_f32_dpp v9, v40, v113 quad_perm:[2,2,2,2] row_mask:0xf bank_mask:0xf
    v_fmac_f32_dpp v10, v40, v114 quad_perm:[2,2,2,2] row_mask:0xf bank_mask:0xf
    v_fmac_f32_dpp v11, v40, v115 quad_perm:[2,2,2,2] row_mask:0xf bank_mask:0xf
    v_fmac_f32_dpp v8, v40, v116 quad_perm:[3,3,3,3] row_mask:0xf bank_mask:0xf
    v_fmac_f32_dpp v9, v40, v117 quad_perm:[3,3,3,3] row_mask:0xf bank_mask:0xf
    v_fmac_f32_dpp v10, v40, v118 quad_perm:[3,3,3,3] row_mask:0xf bank_mask:0xf
    v_fmac_f32_dpp v11, v40, v119 quad_perm:[3,3,3,3] row_mask:0xf bank_mask:0xf
    v_cvt_pk_bf16_f32 v8, v8, v9
    v_cvt_pk_bf16_f32 v9, v10, v11
    ds_write_b64 v180, v[8:9] offset:2560
    ds_read_b128 v[48:51], v181 offset:2560
    ds_read_b128 v[52:55], v181 offset:2624
    ds_read_b128 v[56:59], v181 offset:2688
    ds_read_b128 v[60:63], v181 offset:2752
    s_mov_b32 s46, 0x00030003
    s_mov_b32 s47, 0x00030003
    s_waitcnt lgkmcnt(0)
    v_cmp_ne_u32 vcc, 0, v42
    s_cbranch_vccnz L_latew_61
L_havew_60:
    v_mfma_f32_16x16x32_bf16 v[96:99], v[64:67], v[48:51], 0
    v_mfma_f32_16x16x32_bf16 v[100:103], v[80:83], v[48:51], 0
    v_mfma_f32_16x16x32_bf16 v[96:99], v[68:71], v[52:55], v[96:99]
    v_mfma_f32_16x16x32_bf16 v[100:103], v[84:87], v[52:55], v[100:103]
    v_mfma_f32_16x16x32_bf16 v[96:99], v[72:75], v[56:59], v[96:99]
    v_mfma_f32_16x16x32_bf16 v[100:103], v[88:91], v[56:59], v[100:103]
    v_mfma_f32_16x16x32_bf16 v[96:99], v[76:79], v[60:63], v[96:99]
    v_mfma_f32_16x16x32_bf16 v[100:103], v[92:95], v[60:63], v[100:103]
    s_mov_b64 exec, s[46:47]
    s_nop 5
    ds_write_b128 v184, v[96:99] offset:4608
    ds_write_b128 v184, v[100:103] offset:4736
    ds_write_b32 v191, v190 offset:64
    s_mov_b64 exec, -1
L_anow_55:
    s_cmp_lt_u32 s5, 12
    s_cbranch_scc1 L_aend_56
    s_and_b32 s44, s10, 1
    s_lshl_b32 s44, s44, 4
    v_add_u32 v9, s44, v1
    v_cmp_gt_u32 s[40:41], 27, v9
    v_min_u32 v9, 26, v9
    s_and_b32 s44, s10, 2
    v_mov_b32 v8, s44
    v_mul_u32_u24 v9, 5120, v9
    s_add_u32 s44, s42, 21504
    v_add_u32 v9, s44, v9
    v_and_b32 v10, 1, v2
    v_add_u32 v8, v8, v10
    s_lshl_b32 s44, s100, 6
    v_lshl_add_u32 v13, v8, 4, v9
    v_add_u32 v13, s44, v13
    v_lshrrev_b32 v10, 1, v2
    v_lshl_add_u32 v8, v8, 1, v10
    v_lshl_add_u32 v12, v8, 4, v9
    s_lshl_b32 s44, s100, 7
    v_add_u32 v12, s44, v12
    v_mov_b32 v56, 0x3f803f80
    v_and_b32 v48, v56, v3
    v_and_b32 v49, v56, v4
    v_and_b32 v50, v56, v5
    v_and_b32 v51, v56, v6
    s_mov_b32 s52, 800000
L_poll_62:
    ds_read_b32 v8, v190 offset:88
    s_waitcnt lgkmcnt(0)
    v_cmp_ne_u32 vcc, 0, v8
    s_cbranch_vccnz L_retry_63
L_pdone_64:
    ds_read_b128 v[16:19], v186 offset:0
    ds_read_b128 v[20:23], v186 offset:1024
    ds_read_b128 v[24:27], v186 offset:2048
    ds_read_b128 v[28:31], v186 offset:3072
    ds_read_b128 v[32:35], v186 offset:4096
    ds_read_b128 v[36:39], v186 offset:5120
    ds_read_b128 v[40:43], v186 offset:6144
    ds_read_b128 v[44:47], v186 offset:7168
    s_waitcnt lgkmcnt(0)
    v_mfma_f32_16x16x32_bf16 v[60:63], v[48:51], v[16:19], 0
    v_mfma_f32_16x16x32_bf16 v[60:63], v[48:51], v[20:23], v[60:63]
    v_mfma_f32_16x16x32_bf16 v[60:63], v[48:51], v[24:27], v[60:63]
    v_mfma_f32_16x16x32_bf16 v[60:63], v[48:51], v[28:31], v[60:63]
    v_mfma_f32_16x16x32_bf16 v[60:63], v[48:51], v[32:35], v[60:63]
    v_mfma_f32_16x16x32_bf16 v[60:63], v[48:51], v[36:39], v[60:63]
    v_mfma_f32_16x16x32_bf16 v[60:63], v[48:51], v[40:43], v[60:63]
    v_mfma_f32_16x16x32_bf16 v[60:63], v[48:51], v[44:47], v[60:63]
    s_mov_b32 s46, s40
    s_mov_b32 s47, 0
    s_nop 5
    v_and_or_b32 v60, v60, v7, s12
    v_and_or_b32 v61, v61, v7, s13
    v_and_or_b32 v62, v62, v7, s14
    v_and_or_b32 v63, v63, v7, s15
    s_mov_b64 exec, s[46:47]
    s_cmp_lg_u32 s43, 0
    s_cbranch_scc1 L_sg_65
    global_store_dwordx4 v13, v[60:63], s[38:39] offset:2560
L_sd_66:
    s_mov_b64 exec, -1
    s_mov_b32 s52, 800000
L_poll_67:
    ds_read_b32 v8, v190 offset:80
    ds_read_b128 v[64:67], v179 offset:5632
    ds_read_b128 v[68:71], v179 offset:5648
    s_waitcnt lgkmcnt(0)
    v_cmp_ne_u32 vcc, 0, v8
    s_cbranch_vccnz L_retry_68
L_pdone_69:
    v_and_b32 v48, v64, v3
    v_and_b32 v49, v64, v4
    v_and_b32 v50, v64, v5
    v_and_b32 v51, v64, v6
    v_and_b32 v52, v65, v3
    v_and_b32 v53, v65, v4
    v_and_b32 v54, v65, v5
    v_and_b32 v55, v65, v6
    v_mfma_f32_16x16x32_bf16 v[72:75], v[48:51], v[16:19], 0
    v_and_b32 v48, v66, v3
    v_and_b32 v49, v66, v4
    v_and_b32 v50, v66, v5
    v_and_b32 v51, v66, v6
    v_mfma_f32_16x16x32_bf16 v[72:75], v[52:55], v[20:23], v[72:75]
    v_and_b32 v52, v67, v3
    v_and_b32 v53, v67, v4
    v_and_b32 v54, v67, v5
    v_and_b32 v55, v67, v6
    v_mfma_f32_16x16x32_bf16 v[72:75], v[48:51], v[24:27], v[72:75]
    v_and_b32 v48, v68, v3
    v_and_b32 v49, v68, v4
    v_and_b32 v50, v68, v5
    v_and_b32 v51, v68, v6
    v_mfma_f32_16x16x32_bf16 v[72:75], v[52:55], v[28:31], v[72:75]
    v_and_b32 v52, v69, v3
    v_and_b32 v53, v69, v4
    v_and_b32 v54, v69, v5
    v_and_b32 v55, v69, v6
    v_mfma_f32_16x16x32_bf16 v[72:75], v[48:51], v[32:35], v[72:75]
    v_and_b32 v48, v70, v3
    v_and_b32 v49, v70, v4
    v_and_b32 v50, v70, v5
    v_and_b32 v51, v70, v6
    v_mfma_f32_16x16x32_bf16 v[72:75], v[52:55], v[36:39], v[72:75]
    v_and_b32 v52, v71, v3
    v_and_b32 v53, v71, v4
    v_and_b32 v54, v71, v5
    v_and_b32 v55, v71, v6
    v_mfma_f32_16x16x32_bf16 v[72:75], v[48:51], v[40:43], v[72:75]
    s_nop 0
    v_mfma_f32_16x16x32_bf16 v[72:75], v[52:55], v[44:47], v[72:75]
    s_mov_b64 exec, s[40:41]
    s_nop 6
    v_and_or_b32 v72, v72, v7, s12
    v_and_or_b32 v73, v73, v7, s13
    v_and_or_b32 v74, v74, v7, s14
    v_and_or_b32 v75, v75, v7, s15
    s_cmp_lg_u32 s43, 0
    s_cbranch_scc1 L_sg_70
    global_store_dwordx4 v12, v[72:75], s[38:39] offset:0
L_sd_71:
    s_mov_b64 exec, -1
    s_cmp_lg_u32 s10, 0
    s_cbranch_scc1 L_aend_56
    s_lshl_b32 s44, s100, 8
    s_add_u32 s44, s44, s42
    s_add_u32 s44, s44, 21504
    v_lshlrev_b32 v8, 4, v1
    v_mul_u32_u24 v9, 5120, v2
    v_add3_u32 v80, v8, v9, s44
    v_add_u32 v81, 20480, v80
    v_add_u32 v82, 40960, v80
    v_add_u32 v83, 61440, v80
    v_add_u32 v84, 81920, v80
    v_add_u32 v85, 102400, v80
    v_add_u32 v86, 122880, v80
    s_lshr_b32 s44, s100, 2
    s_lshl_b32 s44, s44, 14
    s_and_b32 s47, s100, 3
    s_lshl_b32 s47, s47, 11
    s_add_u32 s44, s44, s47
    s_add_u32 s44, s44, 1245184
    s_lshl_b32 s45, s4, 8
    s_add_u32 s45, s45, s44
    v_lshl_add_u32 v89, v2, 13, v8
    v_add_u32 v89, s45, v89
    ds_read_b32 v88, v190 offset:108
    s_waitcnt lgkmcnt(0)
    v_and_b32 v88, 8192, v88
    v_add3_u32 v88, v88, s44, v185
    v_and_b32 v8, 1, v1
    v_mul_u32_u24 v8, 1280, v8
    v_lshrrev_b32 v90, 1, v1
    v_lshl_add_u32 v90, v90, 3, v8
    v_lshl_add_u32 v90, v2, 1, v90
    s_lshl_b32 s44, s100, 6
    v_add_u32 v90, s44, v90
    v_and_b32 v8, 1, v1
    v_lshlrev_b32 v8, 7, v8
    v_lshrrev_b32 v91, 1, v1
    v_lshl_add_u32 v91, v91, 2, v8
    v_lshl_add_u32 v91, v2, 5, v91
    ds_read_b32 v92, v91 offset:5632
    v_lshlrev_b32 v93, 3, v2
    v_lshrrev_b32 v93, v93, s11
    v_and_b32 v93, 0xff, v93
    v_mov_b32 v40, s96
    v_mov_b32 v41, s97
    v_mov_b32 v42, s98
    v_mov_b32 v43, s99
    s_mov_b32 s46, -1
    s_mov_b32 s47, 0xffff
    s_waitcnt lgkmcnt(0)
    v_and_b32 v92, 0xffff0000, v92
    s_mov_b32 s52, 100000
L_poll_72:
    global_load_dwordx4 v[16:19], v80, s[38:39] sc1
    global_load_dwordx4 v[20:23], v81, s[38:39] sc1
    global_load_dwordx4 v[24:27], v82, s[38:39] sc1
    global_load_dwordx4 v[28:31], v83, s[38:39] sc1
    global_load_dwordx4 v[32:35], v84, s[38:39] sc1
    global_load_dwordx4 v[36:39], v85, s[38:39] sc1
    s_mov_b64 exec, s[46:47]
    global_load_dwordx4 v[40:43], v86, s[38:39] sc1
    s_mov_b64 exec, -1
    s_waitcnt vmcnt(0)
    v_xor_b32 v16, s96, v16
    v_xor_b32 v17, s97, v17
    v_xor_b32 v18, s98, v18
    v_xor_b32 v19, s99, v19
    v_or3_b32 v44, v16, v17, v18
    v_or_b32 v44, v44, v19
    v_xor_b32 v20, s96, v20
    v_xor_b32 v21, s97, v21
    v_xor_b32 v22, s98, v22
    v_xor_b32 v23, s99, v23
    v_or3_b32 v44, v44, v20, v21
    v_or3_b32 v44, v44, v22, v23
    v_xor_b32 v24, s96, v24
    v_xor_b32 v25, s97, v25
    v_xor_b32 v26, s98, v26
    v_xor_b32 v27, s99, v27
    v_or3_b32 v44, v44, v24, v25
    v_or3_b32 v44, v44, v26, v27
    v_xor_b32 v28, s96, v28
    v_xor_b32 v29, s97, v29
    v_xor_b32 v30, s98, v30
    v_xor_b32 v31, s99, v31
    v_or3_b32 v44, v44, v28, v29
    v_or3_b32 v44, v44, v30, v31
    v_xor_b32 v32, s96, v32
    v_xor_b32 v33, s97, v33
    v_xor_b32 v34, s98, v34
    v_xor_b32 v35, s99, v35
    v_or3_b32 v44, v44, v32, v33
    v_or3_b32 v44, v44, v34, v35
    v_xor_b32 v36, s96, v36
    v_xor_b32 v37, s97, v37
    v_xor_b32 v38, s98, v38
    v_xor_b32 v39, s99, v39
    v_or3_b32 v44, v44, v36, v37
    v_or3_b32 v44, v44, v38, v39
    v_xor_b32 v52, s96, v40
    v_xor_b32 v53, s97, v41
    v_xor_b32 v54, s98, v42
    v_xor_b32 v55, s99, v43
    v_or3_b32 v44, v44, v52, v53
    v_or3_b32 v44, v44, v54, v55
    v_and_b32 v44, 0xff, v44
    v_cmp_ne_u32 vcc, 0, v44
    s_cbranch_vccnz L_retry_73
L_pdone_74:
    v_pk_add_f32 v[16:17], v[16:17], v[20:21]
    v_pk_add_f32 v[18:19], v[18:19], v[22:23]
    v_pk_add_f32 v[24:25], v[24:25], v[28:29]
    v_pk_add_f32 v[26:27], v[26:27], v[30:31]
    v_pk_add_f32 v[32:33], v[32:33], v[36:37]
    v_pk_add_f32 v[34:35], v[34:35], v[38:39]
    v_pk_add_f32 v[16:17], v[16:17], v[24:25]
    v_pk_add_f32 v[18:19], v[18:19], v[26:27]
    v_pk_add_f32 v[32:33], v[32:33], v[52:53]
    v_pk_add_f32 v[34:35], v[34:35], v[54:55]
    v_pk_add_f32 v[48:49], v[16:17], v[32:33]
    v_pk_add_f32 v[50:51], v[18:19], v[34:35]
    s_nop 1
    v_permlane32_swap_b32 v48, v50
    v_permlane32_swap_b32 v49, v51
    v_add_f32 v48, v48, v50
    v_add_f32 v49, v49, v51
    s_nop 1
    v_permlane16_swap_b32 v48, v49
    v_add_f32 v48, v48, v49
    v_and_or_b32 v48, v48, v7, v93
    v_mov_b32 v49, v48
    s_nop 1
    v_permlane16_swap_b32 v48, v49
    v_mov_b32 v50, v48
    v_mov_b32 v51, v49
    s_nop 0
    v_permlane32_swap_b32 v48, v50
    v_permlane32_swap_b32 v49, v51
    s_mov_b32 exec_hi, 0
    global_store_dwordx4 v89, v[48:51], s[38:39] sc1
    s_mov_b64 exec, -1
    s_bfe_u32 s44, s100, 196608
    s_cmp_lg_u32 s44, s4
    s_cbranch_scc1 L_aend_56
    s_mov_b32 s52, 100000
L_poll_75:
    global_load_dwordx4 v[16:19], v88, s[38:39] sc1
    global_load_dwordx4 v[20:23], v88, s[38:39] offset:1024 sc1
    s_waitcnt vmcnt(0)
    v_xor_b32 v16, s12, v16
    v_xor_b32 v17, s13, v17
    v_xor_b32 v18, s14, v18
    v_xor_b32 v19, s15, v19
    v_or3_b32 v24, v16, v17, v18
    v_or_b32 v24, v24, v19
    v_xor_b32 v20, s12, v20
    v_xor_b32 v21, s13, v21
    v_xor_b32 v22, s14, v22
    v_xor_b32 v23, s15, v23
    v_or3_b32 v24, v24, v20, v21
    v_or3_b32 v24, v24, v22, v23
    v_and_b32 v24, 0xff, v24
    v_cmp_ne_u32 vcc, 0, v24
    s_cbranch_vccnz L_retry_76
L_pdone_77:
    v_pk_add_f32 v[16:17], v[16:17], v[20:21]
    v_pk_add_f32 v[18:19], v[18:19], v[22:23]
    s_nop 1
    v_permlane32_swap_b32 v16, v18
    v_permlane32_swap_b32 v17, v19
    v_add_f32 v16, v16, v18
    v_add_f32 v17, v17, v19
    s_nop 1
    v_permlane16_swap_b32 v16, v17
    v_add_f32 v16, v16, v17
    v_cvt_pk_bf16_f32 v16, v16, v16
    v_and_b32 v16, 0xffff0000, v16
    v_add_f32 v16, v16, v92
    v_cvt_pk_bf16_f32 v16, v16, v16
    global_store_short v90, v16, s[34:35]
L_aend_56:
    s_endpgm
L_retry_35:
    s_sleep 1
    s_sub_u32 s52, s52, 1
    s_cbranch_scc0 L_poll_34
    s_branch L_pdone_36
L_retry_38:
    s_sub_u32 s52, s52, 1
    s_cbranch_scc0 L_poll_37
    s_branch L_pdone_39
L_retry_41:
    s_sleep 1
    s_sub_u32 s52, s52, 1
    s_cbranch_scc0 L_poll_40
    s_branch L_pdone_42
L_retry_44:
    s_sleep 1
    s_sub_u32 s52, s52, 1
    s_cbranch_scc0 L_poll_43
    s_branch L_pdone_45
L_retry_47:
    s_sleep 1
    s_sub_u32 s52, s52, 1
    s_cbranch_scc0 L_poll_46
    s_branch L_pdone_48
L_retry_50:
    s_sleep 1
    s_sub_u32 s52, s52, 1
    s_cbranch_scc0 L_poll_49
    s_branch L_pdone_51
L_retry_53:
    s_sub_u32 s52, s52, 1
    s_cbranch_scc0 L_poll_52
    s_branch L_pdone_54
L_retry_58:
    s_sub_u32 s52, s52, 1
    s_cbranch_scc0 L_poll_57
    s_branch L_pdone_59
L_latew_61:
    s_mov_b32 s52, 800000
L_poll_78:
    ds_read_b32 v10, v190 offset:84
    ds_read_b64_tr_b16 v[64:65], v182 offset:16384
    ds_read_b64_tr_b16 v[80:81], v182 offset:16416
    ds_read_b64_tr_b16 v[66:67], v182 offset:16640
    ds_read_b64_tr_b16 v[82:83], v182 offset:16672
    ds_read_b64_tr_b16 v[68:69], v182 offset:18432
    ds_read_b64_tr_b16 v[84:85], v182 offset:18464
    ds_read_b64_tr_b16 v[70:71], v182 offset:18688
    ds_read_b64_tr_b16 v[86:87], v182 offset:18720
    ds_read_b64_tr_b16 v[72:73], v182 offset:20480
    ds_read_b64_tr_b16 v[88:89], v182 offset:20512
    ds_read_b64_tr_b16 v[74:75], v182 offset:20736
    ds_read_b64_tr_b16 v[90:91], v182 offset:20768
    ds_read_b64_tr_b16 v[76:77], v182 offset:22528
    ds_read_b64_tr_b16 v[92:93], v182 offset:22560
    ds_read_b64_tr_b16 v[78:79], v182 offset:22784
    ds_read_b64_tr_b16 v[94:95], v182 offset:22816
    s_waitcnt lgkmcnt(0)
    v_cmp_ne_u32 vcc, 0, v10
    s_cbranch_vccnz L_retry_79
L_pdone_80:
    s_branch L_havew_60
L_retry_63:
    s_sleep 1
    s_sub_u32 s52, s52, 1
    s_cbranch_scc0 L_poll_62
    s_branch L_pdone_64
L_sg_65:
    s_nop 7
    global_store_dwordx4 v13, v[60:63], s[38:39] offset:2560 sc1
    s_nop 1
    s_branch L_sd_66
L_retry_68:
    s_sub_u32 s52, s52, 1
    s_cbranch_scc0 L_poll_67
    s_branch L_pdone_69
L_sg_70:
    s_nop 7
    global_store_dwordx4 v12, v[72:75], s[38:39] offset:0 sc1
    s_nop 1
    s_branch L_sd_71
L_retry_73:
    s_sub_u32 s52, s52, 1
    s_cbranch_scc0 L_poll_72
    s_branch L_pdone_74
L_retry_76:
    s_sub_u32 s52, s52, 1
    s_cbranch_scc0 L_poll_75
    s_branch L_pdone_77
L_retry_79:
    s_sub_u32 s52, s52, 1
    s_cbranch_scc0 L_poll_78
    s_branch L_pdone_80
L_load2:
    s_sub_u32 s100, s5, 12
    s_max_i32 s100, s100, 0
    s_add_u32 s101, s5, 12
    s_cmp_lt_u32 s5, 12
    s_cselect_b32 s101, s5, s101
    s_sub_u32 s44, s5, 8
    s_cmp_ge_u32 s5, 20
    s_cselect_b32 s101, s44, s101
    s_setprio 2
    s_getreg_b32 s54, hwreg(HW_REG_XCC_ID)
    s_and_b32 s54, s54, 0xf
    s_lshl_b32 s44, s6, 10
    s_lshl_b32 s45, s7, 7
    s_add_u32 s44, s44, s45
    s_add_u32 s44, s44, 8192
    v_mov_b32 v11, s44
    v_mov_b32 v15, s54
    s_mul_i32 s44, s4, 655360
    s_min_u32 s45, s5, 19
    s_lshl_b32 s45, s45, 6
    s_add_u32 s45, s44, s45
    v_lshrrev_b32 v8, 2, v0
    v_mul_u32_u24 v8, 1280, v8
    v_and_b32 v9, 3, v0
    v_lshl_add_u32 v8, v9, 4, v8
    v_add_u32 v32, s45, v8
    s_mul_i32 s45, s5, 20480
    s_add_u32 s44, s44, s45
    v_lshlrev_b32 v8, 6, v0
    v_add_u32 v33, s44, v8
    s_sub_u32 s44, s44, s45
    s_add_u32 s45, s5, 0
    s_and_b32 s45, s45, 31
    s_mul_i32 s45, s45, 20480
    s_add_u32 s44, s44, s45
    v_add_u32 v35, s44, v8
    s_min_u32 s44, s101, 26
    s_mul_i32 s44, s44, 5120
    s_mul_i32 s45, s4, 163840
    s_add_u32 s44, s44, s45
    s_add_u32 s44, s44, 2118656
    v_add_u32 v34, s44, v8
    s_mul_i32 s44, s100, 110592
    s_mul_i32 s45, s4, 432
    s_add_u32 s44, s44, s45
    v_mul_u32_u24 v13, 3456, v2
    v_add_u32 v13, s44, v13
    v_lshl_add_u32 v56, v1, 4, v13
    v_min_u32 v8, 10, v1
    v_lshl_add_u32 v57, v8, 4, v13
    v_add_u32 v57, 256, v57
    s_sub_u32 s44, s5, 20
    s_and_b32 s44, s44, 7
    s_mul_i32 s44, s44, 110592
    s_add_u32 s44, s44, s45
    v_lshrrev_b32 v8, 3, v0
    v_mul_u32_u24 v8, 3456, v8
    v_and_b32 v9, 7, v0
    v_lshlrev_b32 v9, 6, v9
    v_min_u32 v9, 428, v9
    v_add3_u32 v58, v8, v9, s44
    s_sub_u32 s44, s5, 14
    s_cmp_ge_u32 s44, 12
    s_cselect_b32 s46, 12, 0
    s_sub_u32 s44, s44, s46
    s_add_u32 s44, s44, 8
    s_min_u32 s44, s44, 19
    s_mul_i32 s44, s44, 110592
    s_add_u32 s44, s44, s45
    v_add3_u32 v59, v8, v9, s44
    s_mov_b64 s[92:93], s[28:29]
    s_mov_b64 s[94:95], s[30:31]
    s_mov_b32 s57, 27648
    s_cmp_lt_u32 s5, 28
    s_cbranch_scc1 L_pd_81
    s_mov_b64 s[92:93], s[32:33]
    s_add_u32 s94, s32, 4096
    s_addc_u32 s95, s33, 0
    s_mov_b32 s57, 8192
    s_sub_u32 s44, s5, 29
    s_lshl_b32 s44, s44, 15
    s_cmp_eq_u32 s5, 28
    s_cselect_b32 s44, 243712, s44
    s_mul_i32 s45, s4, 276480
    s_add_u32 s44, s44, s45
    v_lshlrev_b32 v8, 6, v0
    v_add_u32 v58, s44, v8
L_pd_81:
    s_min_u32 s44, s101, 26
    s_lshl_b32 s44, s44, 3
    s_mul_i32 s45, s4, 216
    s_add_u32 s44, s44, s45
    s_mul_i32 s44, s44, 1280
    v_and_b32 v8, 1, v2
    v_lshlrev_b32 v8, 1, v8
    v_lshrrev_b32 v9, 1, v2
    v_add_u32 v8, v8, v9
    v_mul_u32_u24 v8, 2560, v8
    v_lshl_add_u32 v8, v1, 4, v8
    v_add_u32 v64, s44, v8
    s_lshl_b32 s44, s8, 5
    s_add_u32 s44, s44, s6
    s_lshl_b32 s44, s44, 20
    s_lshl_b32 s45, s9, 16
    s_add_u32 s44, s44, s45
    s_add_u32 s44, s44, 786432
    v_lshlrev_b32 v8, 10, v2
    v_lshl_add_u32 v8, v1, 4, v8
    v_add_u32 v66, s44, v8
    v_and_b32 v8, 7, v0
    v_and_b32 v9, 1, v8
    v_cmp_eq_u32 vcc, 1, v9
    v_mov_b32 v9, 0xffff
    v_mov_b32 v10, 0xffff0000
    v_cndmask_b32 v9, v9, v10, vcc
    v_lshrrev_b32 v8, 1, v8
    v_cmp_eq_u32 vcc, 0, v8
    s_nop 1
    v_cndmask_b32 v3, 0, v9, vcc
    v_cmp_eq_u32 vcc, 1, v8
    s_nop 1
    v_cndmask_b32 v4, 0, v9, vcc
    v_cmp_eq_u32 vcc, 2, v8
    s_nop 1
    v_cndmask_b32 v5, 0, v9, vcc
    v_cmp_eq_u32 vcc, 3, v8
    s_nop 1
    v_cndmask_b32 v6, 0, v9, vcc
    v_mov_b32 v7, 0xffffff00
    s_mov_b32 s53, 0x0c0c0400
    s_mov_b32 s58, 0xff00ff00
    s_mov_b32 s59, 0xff00ff00
    s_waitcnt lgkmcnt(0)
    s_mul_i32 s11, s11, 0x9e3779b1
    s_add_u32 s11, s11, 0x7f4a7c15
    s_xor_b32 s55, s11, 0x5a5a5a5a
    s_and_b32 s12, s11, 0xff
    s_bfe_u32 s13, s11, 0x80008
    s_bfe_u32 s14, s11, 0x80010
    s_lshr_b32 s15, s11, 24
    s_and_b32 s96, s55, 0xff
    s_bfe_u32 s97, s55, 0x80008
    s_bfe_u32 s98, s55, 0x80010
    s_lshr_b32 s99, s55, 24
    v_mov_b32 v14, s11
    s_mov_b64 exec, 1
    global_store_dwordx2 v11, v[14:15], s[38:39] sc1
    s_mov_b64 exec, -1
    s_mov_b32 s52, 800000
L_poll_82:
    ds_read_b128 v[16:19], v190 offset:16
    s_waitcnt lgkmcnt(0)
    v_or3_b32 v16, v16, v17, v18
    v_or_b32 v16, v16, v19
    v_cmp_ne_u32 vcc, 0, v16
    s_cbranch_vccnz L_retry_83
L_pdone_84:
    v_add_u32 v65, 0, v66
    s_mov_b32 m0, 81920
    s_nop 0
    global_load_lds_dwordx4 v65, s[20:21] nt
    v_add_u32 v65, 24576, v66
    s_mov_b32 m0, 82944
    s_nop 0
    global_load_lds_dwordx4 v65, s[20:21] nt
    v_add_u32 v65, 32768, v66
    s_mov_b32 m0, 83968
    s_nop 0
    global_load_lds_dwordx4 v65, s[20:21] nt
    v_add_u32 v65, 57344, v66
    s_mov_b32 m0, 84992
    s_nop 0
    global_load_lds_dwordx4 v65, s[20:21] nt
    v_add_u32 v65, 256, v66
    s_mov_b32 m0, 86016
    s_nop 0
    global_load_lds_dwordx4 v65, s[20:21] nt
    v_add_u32 v65, 24832, v66
    s_mov_b32 m0, 87040
    s_nop 0
    global_load_lds_dwordx4 v65, s[20:21] nt
    v_add_u32 v65, 33024, v66
    s_mov_b32 m0, 88064
    s_nop 0
    global_load_lds_dwordx4 v65, s[20:21] nt
    v_add_u32 v65, 57600, v66
    s_mov_b32 m0, 89088
    s_nop 0
    global_load_lds_dwordx4 v65, s[20:21] nt
    v_add_u32 v65, 512, v66
    s_mov_b32 m0, 90112
    s_nop 0
    global_load_lds_dwordx4 v65, s[20:21] nt
    v_add_u32 v65, 25088, v66
    s_mov_b32 m0, 91136
    s_nop 0
    global_load_lds_dwordx4 v65, s[20:21] nt
    v_add_u32 v65, 33280, v66
    s_mov_b32 m0, 92160
    s_nop 0
    global_load_lds_dwordx4 v65, s[20:21] nt
    v_add_u32 v65, 57856, v66
    s_mov_b32 m0, 93184
    s_nop 0
    global_load_lds_dwordx4 v65, s[20:21] nt
    v_add_u32 v65, 768, v66
    s_mov_b32 m0, 94208
    s_nop 0
    global_load_lds_dwordx4 v65, s[20:21] nt
    v_add_u32 v65, 25344, v66
    s_mov_b32 m0, 95232
    s_nop 0
    global_load_lds_dwordx4 v65, s[20:21] nt
    v_add_u32 v65, 33536, v66
    s_mov_b32 m0, 96256
    s_nop 0
    global_load_lds_dwordx4 v65, s[20:21] nt
    v_add_u32 v65, 58112, v66
    s_mov_b32 m0, 97280
    s_nop 0
    global_load_lds_dwordx4 v65, s[20:21] nt
    v_add_u32 v65, 4096, v66
    s_waitcnt vmcnt(15)
    s_mov_b32 m0, 98304
    s_nop 0
    global_load_lds_dwordx4 v65, s[20:21] nt
    v_add_u32 v65, 28672, v66
    s_waitcnt vmcnt(15)
    s_mov_b32 m0, 99328
    s_nop 0
    global_load_lds_dwordx4 v65, s[20:21] nt
    v_add_u32 v65, 36864, v66
    s_waitcnt vmcnt(15)
    s_mov_b32 m0, 100352
    s_nop 0
    global_load_lds_dwordx4 v65, s[20:21] nt
    v_add_u32 v65, 61440, v66
    s_waitcnt vmcnt(15)
    s_mov_b32 m0, 101376
    s_nop 0
    global_load_lds_dwordx4 v65, s[20:21] nt
    v_add_u32 v65, 4352, v66
    s_waitcnt vmcnt(15)
    s_mov_b32 m0, 102400
    s_nop 0
    global_load_lds_dwordx4 v65, s[20:21] nt
    v_add_u32 v65, 28928, v66
    s_waitcnt vmcnt(15)
    s_mov_b32 m0, 103424
    s_nop 0
    global_load_lds_dwordx4 v65, s[20:21] nt
    v_add_u32 v65, 37120, v66
    s_waitcnt vmcnt(15)
    s_mov_b32 m0, 104448
    s_nop 0
    global_load_lds_dwordx4 v65, s[20:21] nt
    v_add_u32 v65, 61696, v66
    s_waitcnt vmcnt(15)
    s_mov_b32 m0, 105472
    s_nop 0
    global_load_lds_dwordx4 v65, s[20:21] nt
    v_add_u32 v65, 4608, v66
    s_waitcnt vmcnt(15)
    s_mov_b32 m0, 106496
    s_nop 0
    global_load_lds_dwordx4 v65, s[20:21] nt
    v_add_u32 v65, 29184, v66
    s_waitcnt vmcnt(15)
    s_mov_b32 m0, 107520
    s_nop 0
    global_load_lds_dwordx4 v65, s[20:21] nt
    v_add_u32 v65, 37376, v66
    s_waitcnt vmcnt(15)
    s_mov_b32 m0, 108544
    s_nop 0
    global_load_lds_dwordx4 v65, s[20:21] nt
    v_add_u32 v65, 61952, v66
    s_waitcnt vmcnt(15)
    s_mov_b32 m0, 109568
    s_nop 0
    global_load_lds_dwordx4 v65, s[20:21] nt
    v_add_u32 v65, 4864, v66
    s_waitcnt vmcnt(15)
    s_mov_b32 m0, 110592
    s_nop 0
    global_load_lds_dwordx4 v65, s[20:21] nt
    v_add_u32 v65, 29440, v66
    s_waitcnt vmcnt(15)
    s_mov_b32 m0, 111616
    s_nop 0
    global_load_lds_dwordx4 v65, s[20:21] nt
    v_add_u32 v65, 37632, v66
    s_waitcnt vmcnt(15)
    s_mov_b32 m0, 112640
    s_nop 0
    global_load_lds_dwordx4 v65, s[20:21] nt
    v_add_u32 v65, 62208, v66
    s_waitcnt vmcnt(15)
    s_mov_b32 m0, 113664
    s_nop 0
    global_load_lds_dwordx4 v65, s[20:21] nt
    v_add_u32 v65, 8192, v66
    s_waitcnt vmcnt(31)
    s_mov_b32 m0, 114688
    s_nop 0
    global_load_lds_dwordx4 v65, s[20:21] nt
    v_add_u32 v65, 16384, v66
    s_waitcnt vmcnt(31)
    s_mov_b32 m0, 115712
    s_nop 0
    global_load_lds_dwordx4 v65, s[20:21] nt
    v_add_u32 v65, 40960, v66
    s_waitcnt vmcnt(31)
    s_mov_b32 m0, 116736
    s_nop 0
    global_load_lds_dwordx4 v65, s[20:21] nt
    v_add_u32 v65, 49152, v66
    s_waitcnt vmcnt(31)
    s_mov_b32 m0, 117760
    s_nop 0
    global_load_lds_dwordx4 v65, s[20:21] nt
    v_add_u32 v65, 8448, v66
    s_waitcnt vmcnt(31)
    s_mov_b32 m0, 118784
    s_nop 0
    global_load_lds_dwordx4 v65, s[20:21] nt
    v_add_u32 v65, 16640, v66
    s_waitcnt vmcnt(31)
    s_mov_b32 m0, 119808
    s_nop 0
    global_load_lds_dwordx4 v65, s[20:21] nt
    v_add_u32 v65, 41216, v66
    s_waitcnt vmcnt(31)
    s_mov_b32 m0, 120832
    s_nop 0
    global_load_lds_dwordx4 v65, s[20:21] nt
    v_add_u32 v65, 49408, v66
    s_waitcnt vmcnt(31)
    s_mov_b32 m0, 121856
    s_nop 0
    global_load_lds_dwordx4 v65, s[20:21] nt
    v_add_u32 v65, 8704, v66
    s_waitcnt vmcnt(31)
    s_mov_b32 m0, 122880
    s_nop 0
    global_load_lds_dwordx4 v65, s[20:21] nt
    v_add_u32 v65, 16896, v66
    s_waitcnt vmcnt(31)
    s_mov_b32 m0, 123904
    s_nop 0
    global_load_lds_dwordx4 v65, s[20:21] nt
    v_add_u32 v65, 41472, v66
    s_waitcnt vmcnt(31)
    s_mov_b32 m0, 124928
    s_nop 0
    global_load_lds_dwordx4 v65, s[20:21] nt
    v_add_u32 v65, 49664, v66
    s_waitcnt vmcnt(31)
    s_mov_b32 m0, 125952
    s_nop 0
    global_load_lds_dwordx4 v65, s[20:21] nt
    v_add_u32 v65, 8960, v66
    s_waitcnt vmcnt(31)
    s_mov_b32 m0, 126976
    s_nop 0
    global_load_lds_dwordx4 v65, s[20:21] nt
    v_add_u32 v65, 17152, v66
    s_waitcnt vmcnt(31)
    s_mov_b32 m0, 128000
    s_nop 0
    global_load_lds_dwordx4 v65, s[20:21] nt
    v_add_u32 v65, 41728, v66
    s_waitcnt vmcnt(31)
    s_mov_b32 m0, 129024
    s_nop 0
    global_load_lds_dwordx4 v65, s[20:21] nt
    v_add_u32 v65, 49920, v66
    s_waitcnt vmcnt(31)
    s_mov_b32 m0, 130048
    s_nop 0
    global_load_lds_dwordx4 v65, s[20:21] nt
    v_add_u32 v65, 12288, v66
    s_waitcnt vmcnt(31)
    s_mov_b32 m0, 131072
    s_nop 0
    global_load_lds_dwordx4 v65, s[20:21] nt
    v_add_u32 v65, 20480, v66
    s_waitcnt vmcnt(31)
    s_mov_b32 m0, 132096
    s_nop 0
    global_load_lds_dwordx4 v65, s[20:21] nt
    v_add_u32 v65, 45056, v66
    s_waitcnt vmcnt(31)
    s_mov_b32 m0, 133120
    s_nop 0
    global_load_lds_dwordx4 v65, s[20:21] nt
    v_add_u32 v65, 53248, v66
    s_waitcnt vmcnt(31)
    s_mov_b32 m0, 134144
    s_nop 0
    global_load_lds_dwordx4 v65, s[20:21] nt
    v_add_u32 v65, 12544, v66
    s_waitcnt vmcnt(31)
    s_mov_b32 m0, 135168
    s_nop 0
    global_load_lds_dwordx4 v65, s[20:21] nt
    v_add_u32 v65, 20736, v66
    s_waitcnt vmcnt(31)
    s_mov_b32 m0, 136192
    s_nop 0
    global_load_lds_dwordx4 v65, s[20:21] nt
    v_add_u32 v65, 45312, v66
    s_waitcnt vmcnt(31)
    s_mov_b32 m0, 137216
    s_nop 0
    global_load_lds_dwordx4 v65, s[20:21] nt
    v_add_u32 v65, 53504, v66
    s_waitcnt vmcnt(31)
    ds_write_b32 v190, v190 offset:4
    s_mov_b32 m0, 138240
    s_nop 0
    global_load_lds_dwordx4 v65, s[20:21] nt
    v_add_u32 v65, 12800, v66
    s_waitcnt vmcnt(31)
    s_mov_b32 m0, 139264
    s_nop 0
    global_load_lds_dwordx4 v65, s[20:21] nt
    v_add_u32 v65, 20992, v66
    s_waitcnt vmcnt(31)
    s_mov_b32 m0, 140288
    s_nop 0
    global_load_lds_dwordx4 v65, s[20:21] nt
    v_add_u32 v65, 45568, v66
    s_waitcnt vmcnt(31)
    s_mov_b32 m0, 141312
    s_nop 0
    global_load_lds_dwordx4 v65, s[20:21] nt
    v_add_u32 v65, 53760, v66
    s_waitcnt vmcnt(31)
    s_mov_b32 m0, 142336
    s_nop 0
    global_load_lds_dwordx4 v65, s[20:21] nt
    v_add_u32 v65, 13056, v66
    s_waitcnt vmcnt(31)
    s_mov_b32 m0, 143360
    s_nop 0
    global_load_lds_dwordx4 v65, s[20:21] nt
    v_add_u32 v65, 21248, v66
    s_waitcnt vmcnt(31)
    s_mov_b32 m0, 144384
    s_nop 0
    global_load_lds_dwordx4 v65, s[20:21] nt
    v_add_u32 v65, 45824, v66
    s_waitcnt vmcnt(31)
    s_mov_b32 m0, 145408
    s_nop 0
    global_load_lds_dwordx4 v65, s[20:21] nt
    v_add_u32 v65, 54016, v66
    s_waitcnt vmcnt(31)
    s_mov_b32 m0, 146432
    s_nop 0
    global_load_lds_dwordx4 v65, s[20:21] nt
    s_waitcnt vmcnt(31)
    global_load_dword v80, v33, s[24:25]
    v_add_u32 v33, 4096, v33
    s_waitcnt vmcnt(31)
    global_load_dword v81, v33, s[24:25]
    v_add_u32 v33, 4096, v33
    s_waitcnt vmcnt(31)
    global_load_dword v82, v33, s[24:25]
    v_add_u32 v33, 4096, v33
    s_waitcnt vmcnt(31)
    global_load_dword v83, v33, s[24:25]
    v_add_u32 v33, 4096, v33
    s_waitcnt vmcnt(31)
    global_load_dword v84, v33, s[24:25]
    v_add_u32 v33, 4096, v33
    s_waitcnt vmcnt(31)
    global_load_dword v86, v34, s[38:39] offset:0 sc1
    s_waitcnt vmcnt(31)
    global_load_dword v87, v34, s[38:39] offset:1024 sc1
    s_cmp_ge_u32 s5, 20
    s_cbranch_scc1 L_nowo_85
    s_waitcnt vmcnt(23)
    ds_write_b32 v190, v190 offset:8
    s_waitcnt vmcnt(11)
    ds_write_b32 v190, v190 offset:12
    s_waitcnt vmcnt(7)
    ds_write_b32 v190, v190 offset:100
    s_mov_b32 s52, 800000
L_poll_88:
    ds_read_b128 v[16:19], v190 offset:32
    s_waitcnt lgkmcnt(0)
    v_or3_b32 v16, v16, v17, v18
    v_or_b32 v16, v16, v19
    v_and_b32 v16, 1, v16
    v_cmp_ne_u32 vcc, 0, v16
    s_cbranch_vccnz L_retry_89
L_pdone_90:
    s_waitcnt vmcnt(0)
    s_mov_b32 m0, 16384
    s_nop 0
    global_load_lds_dwordx4 v32, s[24:25] nt
    v_add_u32 v32, 20480, v32
    s_mov_b32 m0, 17408
    s_nop 0
    global_load_lds_dwordx4 v32, s[24:25] nt
    v_add_u32 v32, 20480, v32
    s_mov_b32 m0, 18432
    s_nop 0
    global_load_lds_dwordx4 v32, s[24:25] nt
    v_add_u32 v32, 20480, v32
    s_mov_b32 m0, 19456
    s_nop 0
    global_load_lds_dwordx4 v32, s[24:25] nt
    v_add_u32 v32, 20480, v32
    s_mov_b32 m0, 20480
    s_nop 0
    global_load_lds_dwordx4 v32, s[24:25] nt
    v_add_u32 v32, 20480, v32
    s_mov_b32 m0, 21504
    s_nop 0
    global_load_lds_dwordx4 v32, s[24:25] nt
    v_add_u32 v32, 20480, v32
    s_mov_b32 m0, 22528
    s_nop 0
    global_load_lds_dwordx4 v32, s[24:25] nt
    v_add_u32 v32, 20480, v32
    s_mov_b32 m0, 23552
    s_nop 0
    global_load_lds_dwordx4 v32, s[24:25] nt
    v_add_u32 v32, 20480, v32
    s_mov_b32 m0, 24576
    s_nop 0
    global_load_lds_dwordx4 v32, s[24:25] nt
    v_add_u32 v32, 20480, v32
    s_mov_b32 m0, 25600
    s_nop 0
    global_load_lds_dwordx4 v32, s[24:25] nt
    v_add_u32 v32, 20480, v32
    s_mov_b32 m0, 26624
    s_nop 0
    global_load_lds_dwordx4 v32, s[24:25] nt
    v_add_u32 v32, 20480, v32
    s_mov_b32 m0, 27648
    s_nop 0
    global_load_lds_dwordx4 v32, s[24:25] nt
    v_add_u32 v32, 20480, v32
    s_mov_b32 m0, 28672
    s_nop 0
    global_load_lds_dwordx4 v32, s[24:25] nt
    v_add_u32 v32, 20480, v32
    s_mov_b32 m0, 29696
    s_nop 0
    global_load_lds_dwordx4 v32, s[24:25] nt
    v_add_u32 v32, 20480, v32
    s_mov_b32 m0, 30720
    s_nop 0
    global_load_lds_dwordx4 v32, s[24:25] nt
    v_add_u32 v32, 20480, v32
    s_mov_b32 m0, 31744
    s_nop 0
    global_load_lds_dwordx4 v32, s[24:25] nt
    v_add_u32 v32, 20480, v32
    s_mov_b32 m0, 32768
    s_nop 0
    global_load_lds_dwordx4 v32, s[24:25] nt
    v_add_u32 v32, 20480, v32
    s_mov_b32 m0, 33792
    s_nop 0
    global_load_lds_dwordx4 v32, s[24:25] nt
    v_add_u32 v32, 20480, v32
    s_mov_b32 m0, 34816
    s_nop 0
    global_load_lds_dwordx4 v32, s[24:25] nt
    v_add_u32 v32, 20480, v32
    s_mov_b32 m0, 35840
    s_nop 0
    global_load_lds_dwordx4 v32, s[24:25] nt
    v_add_u32 v32, 20480, v32
    s_mov_b32 m0, 36864
    s_nop 0
    global_load_lds_dwordx4 v32, s[24:25] nt
    v_add_u32 v32, 20480, v32
    s_mov_b32 m0, 37888
    s_nop 0
    global_load_lds_dwordx4 v32, s[24:25] nt
    v_add_u32 v32, 20480, v32
    s_mov_b32 m0, 38912
    s_nop 0
    global_load_lds_dwordx4 v32, s[24:25] nt
    v_add_u32 v32, 20480, v32
    s_mov_b32 m0, 39936
    s_nop 0
    global_load_lds_dwordx4 v32, s[24:25] nt
    v_add_u32 v32, 20480, v32
    s_mov_b32 m0, 40960
    s_nop 0
    global_load_lds_dwordx4 v32, s[24:25] nt
    v_add_u32 v32, 20480, v32
    s_mov_b32 m0, 41984
    s_nop 0
    global_load_lds_dwordx4 v32, s[24:25] nt
    v_add_u32 v32, 20480, v32
    s_mov_b32 m0, 43008
    s_nop 0
    global_load_lds_dwordx4 v32, s[24:25] nt
    v_add_u32 v32, 20480, v32
    s_mov_b32 m0, 44032
    s_nop 0
    global_load_lds_dwordx4 v32, s[24:25] nt
    v_add_u32 v32, 20480, v32
    s_mov_b32 m0, 45056
    s_nop 0
    global_load_lds_dwordx4 v32, s[24:25] nt
    v_add_u32 v32, 20480, v32
    s_mov_b32 m0, 46080
    s_nop 0
    global_load_lds_dwordx4 v32, s[24:25] nt
    v_add_u32 v32, 20480, v32
    s_mov_b32 m0, 47104
    s_nop 0
    global_load_lds_dwordx4 v32, s[24:25] nt
    v_add_u32 v32, 20480, v32
    s_mov_b32 m0, 48128
    s_nop 0
    global_load_lds_dwordx4 v32, s[24:25] nt
    v_add_u32 v32, 20480, v32
    s_waitcnt vmcnt(0)
    ds_write_b32 v190, v190 offset:84
    s_mov_b32 s52, 800000
L_poll_91:
    ds_read_b128 v[16:19], v190 offset:112
    s_waitcnt lgkmcnt(0)
    v_or3_b32 v16, v16, v17, v18
    v_or_b32 v16, v16, v19
    v_cmp_ne_u32 vcc, 0, v16
    s_cbranch_vccnz L_retry_92
L_pdone_93:
    s_cmp_lt_u32 s5, 12
    s_cbranch_scc1 L_nogu_87
    s_mov_b32 m0, 49152
    s_nop 0
    global_load_lds_dwordx4 v56, s[28:29] nt
    s_mov_b32 m0, 57344
    s_nop 0
    global_load_lds_dwordx4 v57, s[28:29] nt
    s_mov_b32 m0, 65536
    s_nop 0
    global_load_lds_dwordx4 v56, s[30:31] nt
    s_mov_b32 m0, 73728
    s_nop 0
    global_load_lds_dwordx4 v57, s[30:31] nt
    v_add_u32 v56, 13824, v56
    v_add_u32 v57, 13824, v57
    s_mov_b32 m0, 50176
    s_nop 0
    global_load_lds_dwordx4 v56, s[28:29] nt
    s_mov_b32 m0, 58368
    s_nop 0
    global_load_lds_dwordx4 v57, s[28:29] nt
    s_mov_b32 m0, 66560
    s_nop 0
    global_load_lds_dwordx4 v56, s[30:31] nt
    s_mov_b32 m0, 74752
    s_nop 0
    global_load_lds_dwordx4 v57, s[30:31] nt
    v_add_u32 v56, 13824, v56
    v_add_u32 v57, 13824, v57
    s_mov_b32 m0, 51200
    s_nop 0
    global_load_lds_dwordx4 v56, s[28:29] nt
    s_mov_b32 m0, 59392
    s_nop 0
    global_load_lds_dwordx4 v57, s[28:29] nt
    s_mov_b32 m0, 67584
    s_nop 0
    global_load_lds_dwordx4 v56, s[30:31] nt
    s_mov_b32 m0, 75776
    s_nop 0
    global_load_lds_dwordx4 v57, s[30:31] nt
    v_add_u32 v56, 13824, v56
    v_add_u32 v57, 13824, v57
    s_mov_b32 m0, 52224
    s_nop 0
    global_load_lds_dwordx4 v56, s[28:29] nt
    s_mov_b32 m0, 60416
    s_nop 0
    global_load_lds_dwordx4 v57, s[28:29] nt
    s_mov_b32 m0, 68608
    s_nop 0
    global_load_lds_dwordx4 v56, s[30:31] nt
    s_mov_b32 m0, 76800
    s_nop 0
    global_load_lds_dwordx4 v57, s[30:31] nt
    v_add_u32 v56, 13824, v56
    v_add_u32 v57, 13824, v57
    s_mov_b32 m0, 53248
    s_nop 0
    global_load_lds_dwordx4 v56, s[28:29] nt
    s_mov_b32 m0, 61440
    s_nop 0
    global_load_lds_dwordx4 v57, s[28:29] nt
    s_mov_b32 m0, 69632
    s_nop 0
    global_load_lds_dwordx4 v56, s[30:31] nt
    s_mov_b32 m0, 77824
    s_nop 0
    global_load_lds_dwordx4 v57, s[30:31] nt
    v_add_u32 v56, 13824, v56
    v_add_u32 v57, 13824, v57
    s_mov_b32 m0, 54272
    s_nop 0
    global_load_lds_dwordx4 v56, s[28:29] nt
    s_mov_b32 m0, 62464
    s_nop 0
    global_load_lds_dwordx4 v57, s[28:29] nt
    s_mov_b32 m0, 70656
    s_nop 0
    global_load_lds_dwordx4 v56, s[30:31] nt
    s_mov_b32 m0, 78848
    s_nop 0
    global_load_lds_dwordx4 v57, s[30:31] nt
    v_add_u32 v56, 13824, v56
    v_add_u32 v57, 13824, v57
    s_mov_b32 m0, 55296
    s_nop 0
    global_load_lds_dwordx4 v56, s[28:29] nt
    s_mov_b32 m0, 63488
    s_nop 0
    global_load_lds_dwordx4 v57, s[28:29] nt
    s_mov_b32 m0, 71680
    s_nop 0
    global_load_lds_dwordx4 v56, s[30:31] nt
    s_mov_b32 m0, 79872
    s_nop 0
    global_load_lds_dwordx4 v57, s[30:31] nt
    v_add_u32 v56, 13824, v56
    v_add_u32 v57, 13824, v57
    s_mov_b32 m0, 56320
    s_nop 0
    global_load_lds_dwordx4 v56, s[28:29] nt
    s_mov_b32 m0, 64512
    s_nop 0
    global_load_lds_dwordx4 v57, s[28:29] nt
    s_mov_b32 m0, 72704
    s_nop 0
    global_load_lds_dwordx4 v56, s[30:31] nt
    s_mov_b32 m0, 80896
    s_nop 0
    global_load_lds_dwordx4 v57, s[30:31] nt
    v_add_u32 v56, 13824, v56
    v_add_u32 v57, 13824, v57
    s_cmp_ge_u32 s101, 27
    s_cbranch_scc1 L_nod_94
L_nogu_87:
    s_mov_b32 m0, 6144
    v_add_u32 v65, 0, v64
    global_load_lds_dwordx4 v65, s[32:33] nt
    s_mov_b32 m0, 7168
    v_add_u32 v65, 256, v64
    global_load_lds_dwordx4 v65, s[32:33] nt
    s_mov_b32 m0, 8192
    v_add_u32 v65, 512, v64
    global_load_lds_dwordx4 v65, s[32:33] nt
    s_mov_b32 m0, 9216
    v_add_u32 v65, 768, v64
    global_load_lds_dwordx4 v65, s[32:33] nt
    s_mov_b32 m0, 10240
    v_add_u32 v65, 1024, v64
    global_load_lds_dwordx4 v65, s[32:33] nt
    s_mov_b32 m0, 11264
    v_add_u32 v65, 1280, v64
    global_load_lds_dwordx4 v65, s[32:33] nt
    s_mov_b32 m0, 12288
    v_add_u32 v65, 1536, v64
    global_load_lds_dwordx4 v65, s[32:33] nt
    s_mov_b32 m0, 13312
    v_add_u32 v65, 1792, v64
    global_load_lds_dwordx4 v65, s[32:33] nt
    s_mov_b32 m0, 14336
    v_add_u32 v65, 2048, v64
    global_load_lds_dwordx4 v65, s[32:33] nt
    s_mov_b32 m0, 15360
    v_add_u32 v65, 2304, v64
    global_load_lds_dwordx4 v65, s[32:33] nt
    s_branch L_lfin_86
L_nod_94:
    s_waitcnt vmcnt(0)
    s_branch L_lfin_86
L_nowo_85:
    s_waitcnt vmcnt(23)
    ds_write_b32 v190, v190 offset:8
    s_waitcnt vmcnt(11)
    ds_write_b32 v190, v190 offset:12
    global_load_dword v70, v58, s[92:93]
    s_waitcnt vmcnt(11)
    global_load_dword v71, v58, s[94:95]
    v_add_u32 v58, s57, v58
    s_waitcnt vmcnt(11)
    global_load_dword v72, v58, s[92:93]
    s_waitcnt vmcnt(11)
    global_load_dword v73, v58, s[94:95]
    v_add_u32 v58, s57, v58
    s_waitcnt vmcnt(11)
    ds_write_b32 v190, v190 offset:100
    s_mov_b32 s52, 800000
L_poll_95:
    ds_read_b32 v16, v190 offset:104
    s_waitcnt lgkmcnt(0)
    v_cmp_ne_u32 vcc, 0, v16
    s_cbranch_vccnz L_retry_96
L_pdone_97:
    global_load_dword v74, v58, s[92:93]
    global_load_dword v75, v58, s[94:95]
    v_add_u32 v58, s57, v58
    global_load_dword v76, v58, s[92:93]
    global_load_dword v77, v58, s[94:95]
    v_add_u32 v58, s57, v58
    s_mov_b32 m0, 49152
    s_nop 0
    global_load_lds_dwordx4 v56, s[28:29] nt
    s_mov_b32 m0, 57344
    s_nop 0
    global_load_lds_dwordx4 v57, s[28:29] nt
    s_mov_b32 m0, 65536
    s_nop 0
    global_load_lds_dwordx4 v56, s[30:31] nt
    s_mov_b32 m0, 73728
    s_nop 0
    global_load_lds_dwordx4 v57, s[30:31] nt
    v_add_u32 v56, 13824, v56
    v_add_u32 v57, 13824, v57
    s_mov_b32 m0, 50176
    s_nop 0
    global_load_lds_dwordx4 v56, s[28:29] nt
    s_mov_b32 m0, 58368
    s_nop 0
    global_load_lds_dwordx4 v57, s[28:29] nt
    s_mov_b32 m0, 66560
    s_nop 0
    global_load_lds_dwordx4 v56, s[30:31] nt
    s_mov_b32 m0, 74752
    s_nop 0
    global_load_lds_dwordx4 v57, s[30:31] nt
    v_add_u32 v56, 13824, v56
    v_add_u32 v57, 13824, v57
    s_mov_b32 m0, 51200
    s_nop 0
    global_load_lds_dwordx4 v56, s[28:29] nt
    s_mov_b32 m0, 59392
    s_nop 0
    global_load_lds_dwordx4 v57, s[28:29] nt
    s_mov_b32 m0, 67584
    s_nop 0
    global_load_lds_dwordx4 v56, s[30:31] nt
    s_mov_b32 m0, 75776
    s_nop 0
    global_load_lds_dwordx4 v57, s[30:31] nt
    v_add_u32 v56, 13824, v56
    v_add_u32 v57, 13824, v57
    s_mov_b32 m0, 52224
    s_nop 0
    global_load_lds_dwordx4 v56, s[28:29] nt
    s_mov_b32 m0, 60416
    s_nop 0
    global_load_lds_dwordx4 v57, s[28:29] nt
    s_mov_b32 m0, 68608
    s_nop 0
    global_load_lds_dwordx4 v56, s[30:31] nt
    s_mov_b32 m0, 76800
    s_nop 0
    global_load_lds_dwordx4 v57, s[30:31] nt
    v_add_u32 v56, 13824, v56
    v_add_u32 v57, 13824, v57
    s_mov_b32 m0, 53248
    s_nop 0
    global_load_lds_dwordx4 v56, s[28:29] nt
    s_mov_b32 m0, 61440
    s_nop 0
    global_load_lds_dwordx4 v57, s[28:29] nt
    s_mov_b32 m0, 69632
    s_nop 0
    global_load_lds_dwordx4 v56, s[30:31] nt
    s_mov_b32 m0, 77824
    s_nop 0
    global_load_lds_dwordx4 v57, s[30:31] nt
    v_add_u32 v56, 13824, v56
    v_add_u32 v57, 13824, v57
    s_mov_b32 m0, 54272
    s_nop 0
    global_load_lds_dwordx4 v56, s[28:29] nt
    s_mov_b32 m0, 62464
    s_nop 0
    global_load_lds_dwordx4 v57, s[28:29] nt
    s_mov_b32 m0, 70656
    s_nop 0
    global_load_lds_dwordx4 v56, s[30:31] nt
    s_mov_b32 m0, 78848
    s_nop 0
    global_load_lds_dwordx4 v57, s[30:31] nt
    v_add_u32 v56, 13824, v56
    v_add_u32 v57, 13824, v57
    s_mov_b32 m0, 55296
    s_nop 0
    global_load_lds_dwordx4 v56, s[28:29] nt
    s_mov_b32 m0, 63488
    s_nop 0
    global_load_lds_dwordx4 v57, s[28:29] nt
    s_mov_b32 m0, 71680
    s_nop 0
    global_load_lds_dwordx4 v56, s[30:31] nt
    s_mov_b32 m0, 79872
    s_nop 0
    global_load_lds_dwordx4 v57, s[30:31] nt
    v_add_u32 v56, 13824, v56
    v_add_u32 v57, 13824, v57
    s_mov_b32 m0, 56320
    s_nop 0
    global_load_lds_dwordx4 v56, s[28:29] nt
    s_mov_b32 m0, 64512
    s_nop 0
    global_load_lds_dwordx4 v57, s[28:29] nt
    s_mov_b32 m0, 72704
    s_nop 0
    global_load_lds_dwordx4 v56, s[30:31] nt
    s_mov_b32 m0, 80896
    s_nop 0
    global_load_lds_dwordx4 v57, s[30:31] nt
    v_add_u32 v56, 13824, v56
    v_add_u32 v57, 13824, v57
    s_mov_b32 m0, 6144
    v_add_u32 v65, 0, v64
    global_load_lds_dwordx4 v65, s[32:33] nt
    s_mov_b32 m0, 7168
    v_add_u32 v65, 256, v64
    global_load_lds_dwordx4 v65, s[32:33] nt
    s_mov_b32 m0, 8192
    v_add_u32 v65, 512, v64
    global_load_lds_dwordx4 v65, s[32:33] nt
    s_mov_b32 m0, 9216
    v_add_u32 v65, 768, v64
    global_load_lds_dwordx4 v65, s[32:33] nt
    s_mov_b32 m0, 10240
    v_add_u32 v65, 1024, v64
    global_load_lds_dwordx4 v65, s[32:33] nt
    s_mov_b32 m0, 11264
    v_add_u32 v65, 1280, v64
    global_load_lds_dwordx4 v65, s[32:33] nt
    s_mov_b32 m0, 12288
    v_add_u32 v65, 1536, v64
    global_load_lds_dwordx4 v65, s[32:33] nt
    s_mov_b32 m0, 13312
    v_add_u32 v65, 1792, v64
    global_load_lds_dwordx4 v65, s[32:33] nt
    s_mov_b32 m0, 14336
    v_add_u32 v65, 2048, v64
    global_load_lds_dwordx4 v65, s[32:33] nt
    s_mov_b32 m0, 15360
    v_add_u32 v65, 2304, v64
    global_load_lds_dwordx4 v65, s[32:33] nt
L_lfin_86:
    s_waitcnt vmcnt(10)
    ds_write_b32 v190, v190 offset:88
    s_cmp_ge_u32 s101, 27
    s_cbranch_scc1 L_dend_98
    s_mov_b32 s52, 800000
L_poll_99:
    ds_read_b32 v8, v190 offset:96
    s_waitcnt lgkmcnt(0)
    v_lshrrev_b32 v9, 1, v8
    v_cmp_ne_u32 vcc, 0, v9
    s_cbranch_vccnz L_retry_100
L_pdone_101:
    v_readfirstlane_b32 s44, v8
    s_cmp_eq_u32 s44, 0
    s_cselect_b32 s43, 0, 2097152
    s_mul_i32 s42, s4, 163840
    s_add_u32 s42, s42, 2097152
    s_add_u32 s42, s42, s43
    s_mul_i32 s45, s101, 5120
    s_add_u32 s45, s45, s42
    s_add_u32 s45, s45, 21504
    v_and_b32 v8, 7, v0
    v_lshrrev_b32 v9, 3, v0
    v_lshlrev_b32 v156, 7, v8
    v_lshl_add_u32 v156, v9, 4, v156
    v_add_u32 v156, s45, v156
    v_lshlrev_b32 v157, 6, v1
    v_lshl_add_u32 v157, v2, 4, v157
    v_add_u32 v157, s45, v157
    v_bfe_u32 v158, v0, 3, 1
    v_lshlrev_b32 v158, 5, v158
    v_lshl_add_u32 v158, v2, 3, v158
    v_add_u32 v158, v158, v8
    v_lshlrev_b32 v158, 4, v158
    v_add_u32 v158, s45, v158
    v_and_b32 v159, 1, v2
    v_lshl_add_u32 v159, v1, 1, v159
    v_lshrrev_b32 v9, 1, v2
    v_lshl_add_u32 v159, v159, 1, v9
    v_lshlrev_b32 v159, 4, v159
    v_add_u32 v159, s45, v159
    v_add_u32 v159, 2048, v159
    v_lshlrev_b32 v150, 4, v0
    v_mov_b32 v32, s12
    v_mov_b32 v33, s13
    v_mov_b32 v34, s14
    v_mov_b32 v35, s15
    v_mov_b32 v24, s12
    v_mov_b32 v25, s13
    v_mov_b32 v26, s14
    v_mov_b32 v27, s15
    v_mov_b32 v36, 0
    v_mov_b32 v37, 0
    v_mov_b32 v38, s11
    s_mov_b32 s40, 0x000f000f
    s_mov_b32 s41, 0x000f000f
    s_mov_b32 s52, 100000
L_poll_102:
    global_load_dwordx4 v[28:31], v157, s[38:39] offset:2560 sc1
    s_mov_b64 exec, s[40:41]
    global_load_dwordx4 v[32:35], v157, s[38:39] offset:3584 sc1
    s_mov_b64 exec, -1
    s_waitcnt vmcnt(0)
    v_xor_b32 v28, s12, v28
    v_xor_b32 v29, s13, v29
    v_xor_b32 v30, s14, v30
    v_xor_b32 v31, s15, v31
    v_or3_b32 v48, v28, v29, v30
    v_or_b32 v48, v48, v31
    v_xor_b32 v52, s12, v32
    v_xor_b32 v53, s13, v33
    v_xor_b32 v54, s14, v34
    v_xor_b32 v55, s15, v35
    v_or3_b32 v48, v48, v52, v53
    v_or3_b32 v48, v48, v54, v55
    v_and_b32 v48, 0xff, v48
    v_cmp_ne_u32 vcc, 0, v48
    s_cbranch_vccnz L_retry_103
L_pdone_104:
    ds_read_b128 v[96:99], v150 offset:6144
    ds_read_b128 v[100:103], v150 offset:7168
    ds_read_b128 v[104:107], v150 offset:8192
    ds_read_b128 v[108:111], v150 offset:9216
    ds_read_b128 v[112:115], v150 offset:10240
    ds_read_b128 v[116:119], v150 offset:11264
    ds_read_b128 v[120:123], v150 offset:12288
    ds_read_b128 v[124:127], v150 offset:13312
    ds_read_b128 v[128:131], v150 offset:14336
    ds_read_b128 v[132:135], v150 offset:15360
    v_add_f32 v28, v28, v52
    v_add_f32 v29, v29, v53
    v_add_f32 v30, v30, v54
    v_add_f32 v31, v31, v55
    v_add_f32_dpp v28, v28, v28 quad_perm:[1,0,3,2] row_mask:0xf bank_mask:0xf
    v_add_f32_dpp v29, v29, v29 quad_perm:[1,0,3,2] row_mask:0xf bank_mask:0xf
    v_add_f32_dpp v30, v30, v30 quad_perm:[1,0,3,2] row_mask:0xf bank_mask:0xf
    v_add_f32_dpp v31, v31, v31 quad_perm:[1,0,3,2] row_mask:0xf bank_mask:0xf
    v_add_f32_dpp v28, v28, v28 quad_perm:[2,3,0,1] row_mask:0xf bank_mask:0xf
    v_add_f32_dpp v29, v29, v29 quad_perm:[2,3,0,1] row_mask:0xf bank_mask:0xf
    v_add_f32_dpp v30, v30, v30 quad_perm:[2,3,0,1] row_mask:0xf bank_mask:0xf
    v_add_f32_dpp v31, v31, v31 quad_perm:[2,3,0,1] row_mask:0xf bank_mask:0xf
    v_add_f32_dpp v28, v28, v28 row_half_mirror row_mask:0xf bank_mask:0xf
    v_add_f32_dpp v29, v29, v29 row_half_mirror row_mask:0xf bank_mask:0xf
    v_add_f32_dpp v30, v30, v30 row_half_mirror row_mask:0xf bank_mask:0xf
    v_add_f32_dpp v31, v31, v31 row_half_mirror row_mask:0xf bank_mask:0xf
    v_add_f32_dpp v28, v28, v28 row_ror:8 row_mask:0xf bank_mask:0xf
    v_add_f32_dpp v29, v29, v29 row_ror:8 row_mask:0xf bank_mask:0xf
    v_add_f32_dpp v30, v30, v30 row_ror:8 row_mask:0xf bank_mask:0xf
    v_add_f32_dpp v31, v31, v31 row_ror:8 row_mask:0xf bank_mask:0xf
    s_mov_b32 s40, 0x0f0f0f0f
    s_mov_b32 s41, 0x0f0f0f0f
    s_mov_b32 s46, -1
    s_mov_b32 s47, 0x00000f0f
    s_waitcnt lgkmcnt(0)
    s_mov_b32 s52, 100000
L_poll_105:
    s_mov_b64 exec, s[46:47]
    global_load_dwordx4 v[36:39], v158, s[38:39] offset:3840 sc1
    s_mov_b64 exec, s[40:41]
    global_load_dwordx4 v[24:27], v156, s[38:39] offset:2048 sc1
    s_mov_b64 exec, -1
    global_load_dwordx4 v[16:19], v156, s[38:39] offset:0 sc1
    global_load_dwordx4 v[20:23], v156, s[38:39] offset:1024 sc1
    s_waitcnt vmcnt(0)
    v_xor_b32 v52, s12, v24
    v_xor_b32 v53, s13, v25
    v_xor_b32 v54, s14, v26
    v_xor_b32 v55, s15, v27
    v_or3_b32 v48, v52, v53, v54
    v_or_b32 v48, v48, v55
    v_xor_b32 v16, s12, v16
    v_xor_b32 v17, s13, v17
    v_xor_b32 v18, s14, v18
    v_xor_b32 v19, s15, v19
    v_or3_b32 v48, v48, v16, v17
    v_or3_b32 v48, v48, v18, v19
    v_xor_b32 v20, s12, v20
    v_xor_b32 v21, s13, v21
    v_xor_b32 v22, s14, v22
    v_xor_b32 v23, s15, v23
    v_or3_b32 v48, v48, v20, v21
    v_or3_b32 v48, v48, v22, v23
    v_and_b32 v48, 0xff, v48
    v_sad_u8 v48, v38, s11, v48
    v_cmp_ne_u32 vcc, 0, v48
    s_cbranch_vccnz L_retry_106
L_pdone_107:
    v_add_f32_dpp v36, v36, v36 quad_perm:[1,0,3,2] row_mask:0xf bank_mask:0xf
    v_add_f32_dpp v37, v37, v37 quad_perm:[1,0,3,2] row_mask:0xf bank_mask:0xf
    v_pk_add_f32 v[16:17], v[16:17], v[20:21]
    v_pk_add_f32 v[18:19], v[18:19], v[22:23]
    v_add_f32_dpp v36, v36, v36 quad_perm:[2,3,0,1] row_mask:0xf bank_mask:0xf
    v_add_f32_dpp v37, v37, v37 quad_perm:[2,3,0,1] row_mask:0xf bank_mask:0xf
    v_pk_add_f32 v[16:17], v[16:17], v[52:53]
    v_pk_add_f32 v[18:19], v[18:19], v[54:55]
    v_add_f32_dpp v36, v36, v36 row_half_mirror row_mask:0xf bank_mask:0xf
    v_add_f32_dpp v37, v37, v37 row_half_mirror row_mask:0xf bank_mask:0xf
    v_add_f32_dpp v16, v16, v16 quad_perm:[1,0,3,2] row_mask:0xf bank_mask:0xf
    v_add_f32_dpp v17, v17, v17 quad_perm:[1,0,3,2] row_mask:0xf bank_mask:0xf
    v_add_f32_dpp v18, v18, v18 quad_perm:[1,0,3,2] row_mask:0xf bank_mask:0xf
    v_add_f32_dpp v19, v19, v19 quad_perm:[1,0,3,2] row_mask:0xf bank_mask:0xf
    v_mov_b32 v48, v36
    v_mov_b32 v49, v37
    s_nop 0
    v_permlane16_swap_b32 v36, v48
    v_permlane16_swap_b32 v37, v49
    v_add_f32 v36, v36, v48
    v_add_f32 v37, v37, v49
    v_add_f32_dpp v16, v16, v16 quad_perm:[2,3,0,1] row_mask:0xf bank_mask:0xf
    v_add_f32_dpp v17, v17, v17 quad_perm:[2,3,0,1] row_mask:0xf bank_mask:0xf
    v_add_f32_dpp v18, v18, v18 quad_perm:[2,3,0,1] row_mask:0xf bank_mask:0xf
    v_add_f32_dpp v19, v19, v19 quad_perm:[2,3,0,1] row_mask:0xf bank_mask:0xf
    v_mov_b32 v48, v36
    v_mov_b32 v49, v37
    s_nop 0
    v_permlane32_swap_b32 v36, v48
    v_permlane32_swap_b32 v37, v49
    v_add_f32 v36, v36, v48
    v_add_f32 v37, v37, v49
    v_add_f32_dpp v16, v16, v16 row_half_mirror row_mask:0xf bank_mask:0xf
    v_add_f32_dpp v17, v17, v17 row_half_mirror row_mask:0xf bank_mask:0xf
    v_add_f32_dpp v18, v18, v18 row_half_mirror row_mask:0xf bank_mask:0xf
    v_add_f32_dpp v19, v19, v19 row_half_mirror row_mask:0xf bank_mask:0xf
    v_mul_f32 v36, 0x3acccccd, v36
    v_mul_f32 v37, 0x3acccccd, v37
    v_fma_f32 v37, -v36, v36, v37
    v_max_f32 v37, 0, v37
    v_cvt_pk_bf16_f32 v37, v36, v37
    v_lshlrev_b32 v36, 16, v37
    v_and_b32 v37, 0xffff0000, v37
    v_add_f32 v37, 0x3727c5ac, v37
    v_cvt_pk_bf16_f32 v37, v37, v37
    v_and_b32 v37, 0xffff0000, v37
    v_sqrt_f32 v37, v37
    s_nop 0
    v_cvt_pk_bf16_f32 v37, v37, v37
    v_and_b32 v37, 0xffff0000, v37
    v_rcp_f32 v37, v37
    v_fma_f32 v16, -v36, v28, v16
    v_fma_f32 v17, -v36, v29, v17
    v_fma_f32 v18, -v36, v30, v18
    v_fma_f32 v19, -v36, v31, v19
    v_mul_f32 v16, v16, v37
    v_mul_f32 v17, v17, v37
    v_mul_f32 v18, v18, v37
    v_mul_f32 v19, v19, v37
    s_nop 0
    v_permlane32_swap_b32 v16, v18
    v_permlane32_swap_b32 v17, v19
    v_cvt_pk_bf16_f32 v48, v16, v17
    v_cvt_pk_bf16_f32 v50, v18, v19
    v_and_b32 v49, 0xffff0000, v48
    v_lshlrev_b32 v48, 16, v48
    v_and_b32 v51, 0xffff0000, v50
    v_lshlrev_b32 v50, 16, v50
    v_mul_f32 v52, 0xbfb8aa3b, v48
    v_mul_f32 v53, 0xbfb8aa3b, v49
    v_exp_f32 v52, v52
    v_exp_f32 v53, v53
    v_add_f32 v52, 1.0, v52
    v_add_f32 v53, 1.0, v53
    v_rcp_f32 v52, v52
    v_rcp_f32 v53, v53
    v_mul_f32 v48, v48, v52
    v_mul_f32 v49, v49, v53
    v_cvt_pk_bf16_f32 v48, v48, v49
    v_and_b32 v49, 0xffff0000, v48
    v_lshlrev_b32 v48, 16, v48
    v_mul_f32 v48, v48, v50
    v_mul_f32 v49, v49, v51
    v_cvt_pk_bf16_f32 v48, v48, v48
    v_cvt_pk_bf16_f32 v49, v49, v49
    v_and_b32 v40, v48, v3
    v_and_b32 v41, v48, v4
    v_and_b32 v42, v48, v5
    v_and_b32 v43, v48, v6
    v_and_b32 v44, v49, v3
    v_and_b32 v45, v49, v4
    v_and_b32 v46, v49, v5
    v_and_b32 v47, v49, v6
    v_mfma_f32_16x16x32_bf16 v[56:59], v[40:43], v[96:99], 0
    s_nop 0
    v_mfma_f32_16x16x32_bf16 v[56:59], v[44:47], v[116:119], v[56:59]
    v_mfma_f32_16x16x32_bf16 v[60:63], v[40:43], v[100:103], 0
    v_mfma_f32_16x16x32_bf16 v[60:63], v[44:47], v[120:123], v[60:63]
    v_mfma_f32_16x16x32_bf16 v[64:67], v[40:43], v[104:107], 0
    v_mfma_f32_16x16x32_bf16 v[64:67], v[44:47], v[124:127], v[64:67]
    v_mfma_f32_16x16x32_bf16 v[68:71], v[40:43], v[108:111], 0
    v_mfma_f32_16x16x32_bf16 v[68:71], v[44:47], v[128:131], v[68:71]
    v_mfma_f32_16x16x32_bf16 v[72:75], v[40:43], v[112:115], 0
    v_mfma_f32_16x16x32_bf16 v[72:75], v[44:47], v[132:135], v[72:75]
    s_cmp_lg_u32 s43, 0
    s_cbranch_scc1 L_sg_108
    v_and_or_b32 v56, v56, v7, s96
    v_and_or_b32 v57, v57, v7, s97
    v_and_or_b32 v58, v58, v7, s98
    v_and_or_b32 v59, v59, v7, s99
    global_store_dwordx4 v159, v[56:59], s[38:39] offset:-2048
    v_and_or_b32 v60, v60, v7, s96
    v_and_or_b32 v61, v61, v7, s97
    v_and_or_b32 v62, v62, v7, s98
    v_and_or_b32 v63, v63, v7, s99
    global_store_dwordx4 v159, v[60:63], s[38:39] offset:-1024
    v_and_or_b32 v64, v64, v7, s96
    v_and_or_b32 v65, v65, v7, s97
    v_and_or_b32 v66, v66, v7, s98
    v_and_or_b32 v67, v67, v7, s99
    global_store_dwordx4 v159, v[64:67], s[38:39] offset:0
    v_and_or_b32 v68, v68, v7, s96
    v_and_or_b32 v69, v69, v7, s97
    v_and_or_b32 v70, v70, v7, s98
    v_and_or_b32 v71, v71, v7, s99
    global_store_dwordx4 v159, v[68:71], s[38:39] offset:1024
    v_and_or_b32 v72, v72, v7, s96
    v_and_or_b32 v73, v73, v7, s97
    v_and_or_b32 v74, v74, v7, s98
    v_and_or_b32 v75, v75, v7, s99
    global_store_dwordx4 v159, v[72:75], s[38:39] offset:2048
L_sd_109:
L_dend_98:
    s_endpgm
L_retry_83:
    s_sleep 1
    s_sub_u32 s52, s52, 1
    s_cbranch_scc0 L_poll_82
    s_branch L_pdone_84
L_retry_89:
    s_sleep 1
    s_sub_u32 s52, s52, 1
    s_cbranch_scc0 L_poll_88
    s_branch L_pdone_90
L_retry_92:
    s_sleep 1
    s_sub_u32 s52, s52, 1
    s_cbranch_scc0 L_poll_91
    s_branch L_pdone_93
L_retry_96:
    s_sub_u32 s52, s52, 1
    s_cbranch_scc0 L_poll_95
    s_branch L_pdone_97
L_retry_100:
    s_sleep 1
    s_sub_u32 s52, s52, 1
    s_cbranch_scc0 L_poll_99
    s_branch L_pdone_101
L_retry_103:
    s_sleep 2
    s_sub_u32 s52, s52, 1
    s_cbranch_scc0 L_poll_102
    s_branch L_pdone_104
L_retry_106:
    s_sub_u32 s52, s52, 1
    s_cbranch_scc0 L_poll_105
    s_branch L_pdone_107
L_sg_108:
    s_nop 7
    v_and_or_b32 v56, v56, v7, s96
    v_and_or_b32 v57, v57, v7, s97
    v_and_or_b32 v58, v58, v7, s98
    v_and_or_b32 v59, v59, v7, s99
    global_store_dwordx4 v159, v[56:59], s[38:39] offset:-2048 sc1
    v_and_or_b32 v60, v60, v7, s96
    v_and_or_b32 v61, v61, v7, s97
    v_and_or_b32 v62, v62, v7, s98
    v_and_or_b32 v63, v63, v7, s99
    global_store_dwordx4 v159, v[60:63], s[38:39] offset:-1024 sc1
    v_and_or_b32 v64, v64, v7, s96
    v_and_or_b32 v65, v65, v7, s97
    v_and_or_b32 v66, v66, v7, s98
    v_and_or_b32 v67, v67, v7, s99
    global_store_dwordx4 v159, v[64:67], s[38:39] offset:0 sc1
    v_and_or_b32 v68, v68, v7, s96
    v_and_or_b32 v69, v69, v7, s97
    v_and_or_b32 v70, v70, v7, s98
    v_and_or_b32 v71, v71, v7, s99
    global_store_dwordx4 v159, v[68:71], s[38:39] offset:1024 sc1
    v_and_or_b32 v72, v72, v7, s96
    v_and_or_b32 v73, v73, v7, s97
    v_and_or_b32 v74, v74, v7, s98
    v_and_or_b32 v75, v75, v7, s99
    global_store_dwordx4 v159, v[72:75], s[38:39] offset:2048 sc1
    s_nop 1
    s_branch L_sd_109
L_exit:
    s_endpgm
.section .rodata,"a"
.p2align 6
.amdhsa_kernel sequential_preLN__sliding_block_cached__swiglu_ffn__decode_kernel
  .amdhsa_next_free_vgpr 208
  .amdhsa_next_free_sgpr 102
  .amdhsa_accum_offset 208
  .amdhsa_group_segment_fixed_size 0
  .amdhsa_kernarg_size 96
  .amdhsa_user_sgpr_count 2
  .amdhsa_user_sgpr_kernarg_segment_ptr 1
  .amdhsa_system_sgpr_workgroup_id_x 1
  .amdhsa_float_denorm_mode_32 3
.end_amdhsa_kernel
```
